```python
import torch

def _softmax(x, axis=-1):
    return torch.softmax(x, dim=axis)
def _gelu(x):
    return torch.nn.functional.gelu(x, approximate="tanh")
def _silu(x):
    return torch.nn.functional.silu(x)
def _sigmoid(x):
    return torch.sigmoid(x)
def _layernorm(x, axis=-1, eps=1e-5):
    m = x.mean(dim=axis, keepdim=True)
    v = x.var(dim=axis, keepdim=True, unbiased=False)
    return (x - m) / torch.sqrt(v + eps)
def _scatter_add(tgt, idx, src, axis=0):
    return tgt.clone().index_add_(axis, idx, src)
def _segment_sum(src, seg, n):
    out = torch.zeros((n,) + src.shape[1:], dtype=src.dtype)
    return out.index_add_(0, seg, src)
def _pad(x, pw):
    flat = tuple(v for pair in reversed(pw) for v in pair)
    return torch.nn.functional.pad(x, flat)

kernel_name = 'gated_mix__linear_attn_block__sliding_block__prompt'

def setup_inputs():

    _w = (lambda a: (lambda t: t.to(torch.bfloat16) if t.is_floating_point() else t)(torch.as_tensor(a)))
    def _A_setup():
        B, S, D = 1, 2048, 1024
        return {
            "x": _w((lambda *s: torch.randn(*s, dtype=torch.bfloat16) * 0.05)(B, S, D)),
            "wqkv": _w((lambda *s: torch.randn(*s, dtype=torch.bfloat16) * 1.6)(D, 3 * D)),
            "wo": _w((lambda *s: torch.randn(*s, dtype=torch.bfloat16) * 0.4)(D, D)),
        }
    _A_in = _A_setup()

    def _B_setup():
        B, S, D = 1, 2048, 1024
        return {
            "x": _w((lambda *s: torch.randn(*s, dtype=torch.bfloat16) * 0.05)(B, S, D)),
            "wqkv": _w((lambda *s: torch.randn(*s, dtype=torch.bfloat16) * 0.8)(D, 3 * D)),
            "wo": _w((lambda *s: torch.randn(*s, dtype=torch.bfloat16) * 0.05)(D, D)),
        }
    _B_in = _B_setup()

    return {
        "A_x": _A_in["x"],
        "A_wqkv": _A_in["wqkv"],
        "A_wo": _A_in["wo"],
        "B_x": _B_in["x"],
        "B_wqkv": _B_in["wqkv"],
        "B_wo": _B_in["wo"],
        "gate_w": _w((lambda *s: torch.randn(*s, dtype=torch.bfloat16) * 0.05)(1024) * 16.0),
    }

def reference(A_x, A_wqkv, A_wo, B_x, B_wqkv, B_wo, gate_w):
    def _A_ref(x, wqkv, wo):
        B, S, D = x.shape
        H = 32; Dh = D // H
        qkv = (lambda x, *d: x.permute(*d))((x @ wqkv).reshape(B, S, 3, H, Dh), 2, 0, 3, 1, 4)
        q, k, v = qkv[0], qkv[1], qkv[2]
        phi = lambda t: torch.where(t > 0, t + 1, torch.exp(t)) + 1e-6
        pq, pk = phi(q), phi(k)
        kv = torch.einsum("bhsd,bhse->bhde", pk, v)
        z = torch.einsum("bhsd->bhd", pk)
        num = torch.einsum("bhqd,bhde->bhqe", pq, kv)
        den = torch.einsum("bhqd,bhd->bhq", pq, z)[..., None] + 1e-6
        o = num / den
        return (lambda x, *d: x.permute(*d))(o, 0, 2, 1, 3).reshape(B, S, D) @ wo

    def _B_ref(x, wqkv, wo):
        B, S, D = x.shape
        H = 32; Dh = D // H; W = 256
        qkv = (lambda x, *d: x.permute(*d))((x @ wqkv).reshape(B, S, 3, H, Dh), 2, 0, 3, 1, 4)
        q, k, v = qkv[0], qkv[1], qkv[2]
        scores = torch.einsum("bhqd,bhkd->bhqk", q, k) * (Dh ** -0.5)
        idx = torch.arange(S)
        mask = (idx[:, None] - idx[None, :] >= 0) & (idx[:, None] - idx[None, :] < W)
        scores = torch.where(mask[None, None], scores, -1e9)
        p = _softmax(scores, axis=-1)
        o = torch.einsum("bhqk,bhkd->bhqd", p, v)
        return (lambda x, *d: x.permute(*d))(o, 0, 2, 1, 3).reshape(B, S, D) @ wo

    x = A_x
    g = _sigmoid((x * gate_w).sum(-1, keepdims=True))
    a = _A_ref(x, A_wqkv, A_wo)
    b = _B_ref(x, B_wqkv, B_wo)
    return g * a + (1 - g) * b
```

```asm
; @launch grid=(256,1,1) block=(256,1,1) lds=163840
.amdgcn_target "amdgcn-amd-amdhsa--gfx950"
.text
.globl gated_mix__linear_attn_block__sliding_block__prompt_kernel
.p2align 8
.type gated_mix__linear_attn_block__sliding_block__prompt_kernel,@function
gated_mix__linear_attn_block__sliding_block__prompt_kernel:
s_cmp_ge_u32 s2, 256
s_cbranch_scc1 L_end
s_load_dwordx4 s[4:7], s[0:1], 0
s_load_dwordx4 s[60:63], s[0:1], 32
s_load_dwordx2 s[44:45], s[0:1], 16
s_load_dwordx4 s[64:67], s[0:1], 48
s_load_dwordx4 s[36:39], s[0:1], 64
v_lshrrev_b32 v1, 6, v0
v_and_b32 v2, 63, v0
s_and_b32 s20, s2, 7
v_readfirstlane_b32 s24, v1
s_getpc_b64 s[34:35]
L_pc:
s_bfe_u32 s25, s2, 0x50003
s_lshl_b32 s25, s25, 11
v_lshrrev_b32 v1, 4, v0
v_lshl_add_u32 v1, v1, 7, s25
v_min_u32 v1, L_tail-L_pc, v1
global_load_dword v0, v1, s[34:35]
s_lshr_b32 s21, s2, 3
s_and_b32 s22, s21, 1
s_lshl_b32 s23, s20, 1
s_add_u32 s22, s22, s23
s_lshr_b32 s21, s21, 1
s_lshl_b32 s26, s21, 7
s_lshl_b32 s25, s24, 5
v_lshrrev_b32 v3, 3, v2
s_add_u32 s25, s25, s26
v_add_u32 v3, s25, v3
v_lshrrev_b32 v34, 4, v2
v_and_b32 v5, 7, v2
v_xor_b32 v4, v34, v5
v_lshlrev_b32 v4, 4, v4
v_lshl_add_u32 v10, v3, 11, v4
s_lshl_b32 s27, s24, 12
s_mov_b32 s30, 0
s_mov_b32 s10, 0x400000
s_mov_b32 s11, 0x20000
s_waitcnt lgkmcnt(0)
s_mov_b64 s[8:9], s[4:5]
s_add_u32 m0, s27, 0
s_nop 0
buffer_load_dwordx4 v10, s[8:11], s30 offen offset:0  lds
v_xor_b32 v11, 64, v10
v_add_u32 v11, 15360, v11
v_add_u32 v12, 30720, v10
v_add_u32 v13, 30720, v11
buffer_load_dwordx4 v11, s[8:11], s30 offen offset:1024  lds
v_bfe_u32 v3, v2, 2, 3
s_lshr_b32 s29, s24, 1
s_and_b32 s23, s24, 1
s_lshl_b32 s25, s24, 4
v_add_u32 v3, s25, v3
v_mul_u32_u24 v3, 6144, v3
v_and_b32 v6, 3, v2
v_lshlrev_b32 v4, 4, v6
v_lshrrev_b32 v5, 5, v2
buffer_load_dwordx4 v12, s[8:11], s30 offen offset:2048  lds
v_lshl_add_u32 v4, v5, 6, v4
s_lshl_b32 s25, s22, 7
v_add3_u32 v14, v3, v4, s25
s_mul_i32 s28, s24, 6144
s_add_u32 s28, s28, 32768
s_mov_b32 s31, 0
s_mov_b32 s42, 0x600000
s_mov_b32 s43, 0x20000
s_mov_b64 s[40:41], s[60:61]
buffer_load_dwordx4 v13, s[8:11], s30 offen offset:3072  lds
s_add_u32 s30, s30, 128
v_add_u32 v15, 1024, v14
v_add_u32 v16, 2048, v14
s_mov_b32 s14, 0x600000
s_mov_b32 s15, 0x20000
s_mov_b64 s[12:13], s[6:7]
s_add_u32 m0, s28, 0
s_nop 0
buffer_load_dwordx4 v14, s[40:43], s31 offen offset:0  lds
v_xor_b32 v17, 32, v14
v_add_u32 v17, 49152, v17
v_add_u32 v18, 1024, v17
v_add_u32 v19, 2048, v17
buffer_load_dwordx4 v15, s[40:43], s31 offen offset:1024  lds
s_mul_i32 s3, s21, 24576
s_add_u32 s3, s3, s25
s_lshl_b32 s25, s2, 14
s_cmp_lt_u32 s24, 2
s_cselect_b32 s3, s3, s25
s_movk_i32 s68, 128
s_cselect_b32 s68, 393216, s68
s_movk_i32 s69, 2048
s_cselect_b32 s69, 6144, s69
s_cselect_b32 s70, 11, 13
s_cselect_b32 s71, 12, 8
buffer_load_dwordx4 v16, s[40:43], s31 offen offset:2048  lds
s_cmp_eq_u32 s24, 3
s_cselect_b32 s25, 0, s71
v_mul_u32_u24 v3, s69, v6
v_bfe_u32 v6, v2, 2, 2
v_lshl_add_u32 v33, v6, s70, v3
s_add_u32 m0, s28, 3072
s_nop 0
buffer_load_dwordx4 v17, s[40:43], s31 offen offset:0  lds
v_mad_u32_u24 v6, v34, s68, v33
v_and_b32 v35, 15, v2
v_mov_b32 v7, 0x7fffffe0
v_cmp_gt_u32 vcc, s25, v35
buffer_load_dwordx4 v18, s[40:43], s31 offen offset:1024  lds
s_nop 0
v_cndmask_b32 v32, v7, v6, vcc
v_cmp_gt_u32 vcc, 3, v34
buffer_load_dwordx4 v19, s[40:43], s31 offen offset:2048  lds
s_nop 0
v_cndmask_b32 v32, v7, v32, vcc
s_cmp_lt_u32 s24, 2
s_cselect_b64 s[4:5], s[12:13], s[8:9]
s_cselect_b32 s6, s14, s10
s_cmp_eq_u32 s24, 1
s_cselect_b64 s[4:5], s[40:41], s[4:5]
s_mov_b32 s7, 0x20000
buffer_load_dword v0, v32, s[4:7], s3 offen
s_mul_i32 s25, s68, 3
s_add_u32 s3, s3, s25
s_mov_b64 s[48:49], s[62:63]
s_mov_b64 s[56:57], s[64:65]
s_movk_i32 s58, 2048
s_mov_b32 s59, 0x20000
s_lshl_b32 s25, s24, 10
s_add_u32 m0, s25, 131072
v_lshlrev_b32 v3, 4, v2
buffer_load_dwordx4 v3, s[56:59], s25 offen lds
s_mov_b64 s[56:57], s[66:67]
s_mov_b64 s[52:53], s[36:37]
s_mov_b64 s[16:17], s[38:39]
s_lshl_b32 s25, s21, 1
s_add_u32 s61, s25, s29
s_and_b32 s25, s2, 1
s_cmp_eq_u32 s25, 1
s_cselect_b64 s[64:65], s[48:49], s[44:45]
s_cmp_lt_u32 s24, 2
s_cselect_b32 s69, 128, 0
s_cmp_eq_u32 s24, 2
s_cselect_b32 s69, 0x20000, s69
s_lshr_b32 s25, s2, 1
s_lshl_b32 s25, s25, 14
s_cmp_eq_u32 s24, 3
s_cselect_b64 s[4:5], s[64:65], s[4:5]
s_cselect_b32 s6, 0x200000, s6
s_cselect_b32 s3, s25, s3
s_cselect_b32 s37, 1664, s68
s_cselect_b32 s71, 13, s71
s_cselect_b32 s69, 0x10000, s69
s_cselect_b64 vcc, -1, 0
v_lshlrev_b32 v3, 7, v35
v_cndmask_b32 v6, v33, v3, vcc
s_lshl_b32 s70, s69, 1
s_cmp_lt_u32 s24, 2
s_cselect_b32 s70, 24576, s70
v_and_b32 v3, 1, v34
v_mad_u32_u24 v6, v3, s69, v6
v_mad_u32_u24 v6, v5, s70, v6
v_cmp_gt_u32 vcc, s71, v35
s_and_b32 s25, s22, 1
s_and_b32 s71, s21, 1
v_cndmask_b32 v6, v7, v6, vcc
s_mul_i32 s69, s69, s25
s_sub_u32 s3, s3, s69
s_mul_i32 s69, s70, s71
s_sub_u32 s3, s3, s69
s_mov_b32 s62, s3
s_cmp_eq_u32 s24, 3
s_cselect_b32 s3, 0x40000000, s3
s_lshl_b32 s25, s25, 1
s_add_u32 s25, s25, s71
v_cmp_eq_u32 vcc, s25, v5
s_nop 1
v_cndmask_b32 v26, v7, v6, vcc
s_mov_b32 s18, 0x10000000
s_mov_b32 s19, 0x20000
s_mov_b32 s46, 0x200000
s_mov_b32 s47, 0x20000
s_mov_b32 s50, 0x200000
s_mov_b32 s51, 0x20000
s_mov_b32 s54, 0x100
s_mov_b32 s55, 0x20000
s_mov_b32 s58, 0x400000
s_mov_b32 s59, 0x20000
s_lshl_b32 s25, s22, 1
s_add_u32 s36, s25, s23
s_lshl_b32 s25, s36, 5
s_add_u32 s25, s25, s61
s_lshl_b32 s25, s25, 2
s_add_u32 s60, s25, 8519680
s_lshl_b32 s100, s61, 12
s_add_u32 s100, s100, 8388608
s_lshr_b32 s25, s36, 2
s_lshl_b32 s33, s25, 7
s_and_b32 s25, s36, 3
s_lshl_b32 s25, s25, 2
s_add_u32 s33, s33, s25
s_add_u32 s33, s33, s100
s_lshl_b32 s101, s36, 4
s_add_u32 s101, s101, s100
v_cmp_eq_u32 vcc, 0, v2
v_mov_b32 v1, 0
s_nop 0
v_cndmask_b32 v9, v7, v1, vcc
v_mov_b32 v36, 0
v_mov_b32 v37, 0
v_mov_b32 v38, 0
v_mov_b32 v39, 0
v_lshlrev_b32 v8, 4, v2
s_sub_u32 s25, s60, 128
v_mov_b32 v6, s25
s_lshl_b32 s25, s36, 7
s_add_u32 s25, s25, s100
v_mov_b32 v4, s25
v_cmp_gt_u32 vcc, 8, v2
s_cmp_eq_u32 s61, 0
s_cselect_b32 s25, 16, 8
v_cndmask_b32 v6, v6, v4, vcc
v_add_u32 v8, v8, v6
v_cmp_gt_u32 vcc, s25, v2
s_nop 1
v_cndmask_b32 v8, v7, v8, vcc
buffer_store_dwordx4 v[36:39], v8, s[16:19], 0 offen sc1
s_lshl_b32 s25, s36, 5
s_add_u32 s25, s25, s61
s_mul_i32 s66, s25, 12544
s_add_u32 s66, s66, 8523776
v_and_b32 v3, 15, v2
v_bfe_u32 v4, v2, 1, 3
v_lshrrev_b32 v6, 4, v2
v_xor_b32 v4, v4, v6
v_lshlrev_b32 v4, 4, v4
v_lshl_add_u32 v4, v3, 7, v4
s_lshl_b32 s25, s29, 13
v_add_u32 v20, s25, v4
v_xor_b32 v21, 64, v20
v_bfe_u32 v4, v2, 4, 1
v_mul_u32_u24 v3, 3104, v4
v_mul_u32_u24 v6, 6144, v5
v_add_u32 v3, v3, v6
v_bfe_u32 v4, v2, 2, 2
v_lshl_add_u32 v3, v4, 6, v3
v_and_b32 v4, 3, v2
v_lshl_add_u32 v3, v4, 3, v3
s_lshl_b32 s25, s23, 9
s_add_u32 s25, s25, 32768
v_add_u32 v22, s25, v3
v_xor_b32 v23, 32, v22
v_add_u32 v24, 49152, v22
v_add_u32 v25, 49152, v23
s_mov_b32 s32, 0x358637bd
v_mov_b32 v68, s32
v_mov_b32 v69, s32
v_mov_b32 v70, s32
v_mov_b32 v71, s32
s_getreg_b32 s25, hwreg(HW_REG_XCC_ID, 0, 4)
s_mul_i32 s64, s25, s25
s_lshl_b32 s64, s64, 16
s_lshl_b32 s25, s25, 8
s_add_u32 s64, s64, s25
s_add_u32 s64, s64, 1
v_mov_b32 v28, s64
s_lshl_b32 s25, s22, 4
s_cmp_eq_u32 s24, 0
s_cselect_b32 s65, s25, 0x1000
s_and_b32 s38, s21, 3
s_add_u32 s38, s38, 1
v_and_b32 v29, 15, v2
v_lshlrev_b32 v29, 4, v29
v_lshlrev_b32 v3, 4, v2
v_lshlrev_b32 v6, 7, v2
v_cmp_gt_u32 vcc, 49, v2
s_mov_b32 s67, s66
s_nop 0
v_cndmask_b32 v27, v7, v6, vcc
s_lshr_b32 s25, s2, 3
s_lshr_b32 s26, s20, 1
s_lshl_b32 s26, s26, 3
s_and_b32 s70, s25, 7
s_add_u32 s26, s26, s70
s_and_b32 s70, s20, 1
s_lshl_b32 s70, s70, 2
s_lshr_b32 s25, s25, 3
s_add_u32 s70, s70, s25
s_lshl_b32 s70, s70, 1
s_add_u32 s70, s70, s23
s_lshl_b32 s70, s70, 7
s_lshl_b32 s71, s24, 12
s_and_b32 s20, s26, 7
s_lshr_b32 s20, s20, 0
s_and_b32 s25, s25, 0
s_lshl_b32 s25, s25, 0
s_xor_b32 s20, s20, s25
s_lshl_b32 s20, s20, 17
v_bfe_u32 v56, v2, 2, 3
s_lshl_b32 s25, s29, 5
v_add_u32 v56, s25, v56
v_lshlrev_b32 v56, 11, v56
v_and_b32 v57, 3, v2
v_bfe_u32 v30, v2, 4, 1
v_lshlrev_b32 v58, 1, v30
v_xor_b32 v57, v57, v58
v_lshlrev_b32 v57, 4, v57
v_lshl_add_u32 v57, v5, 6, v57
v_add3_u32 v60, v56, v57, s70
v_add_u32 v61, 15360, v60
v_add_u32 v62, 30720, v60
v_add_u32 v63, 46080, v60
v_lshlrev_b32 v56, 10, v5
v_mul_u32_u24 v57, 288, v30
v_add_u32 v56, v56, v57
v_bfe_u32 v57, v2, 2, 2
v_lshl_add_u32 v56, v57, 6, v56
v_and_b32 v57, 3, v2
v_lshl_add_u32 v56, v57, 3, v56
s_add_u32 s25, s71, 98304
v_add_u32 v58, s25, v56
v_xor_b32 v59, 32, v58
v_and_b32 v40, 31, v2
v_lshlrev_b32 v41, 3, v5
v_sub_u32 v40, v41, v40
s_mov_b32 s25, 0xffff
v_pk_add_u16 v41, v40, s25 op_sel_hi:[0,1]
v_pk_ashrrev_i16 v32, 15, v41 op_sel_hi:[0,1]
s_mov_b32 s25, 0x20001
v_pk_add_u16 v41, v40, s25 op_sel_hi:[0,1]
v_pk_ashrrev_i16 v33, 15, v41 op_sel_hi:[0,1]
s_mov_b32 s25, 0x10000f
v_pk_add_u16 v41, v40, s25 op_sel_hi:[0,1]
v_pk_ashrrev_i16 v34, 15, v41 op_sel_hi:[0,1]
s_mov_b32 s25, 0x120011
v_pk_add_u16 v41, v40, s25 op_sel_hi:[0,1]
v_pk_ashrrev_i16 v35, 15, v41 op_sel_hi:[0,1]
s_mov_b32 s25, 0x40003
v_pk_add_u16 v41, v40, s25 op_sel_hi:[0,1]
v_pk_ashrrev_i16 v36, 15, v41 op_sel_hi:[0,1]
s_mov_b32 s25, 0x60005
v_pk_add_u16 v41, v40, s25 op_sel_hi:[0,1]
v_pk_ashrrev_i16 v37, 15, v41 op_sel_hi:[0,1]
s_mov_b32 s25, 0x140013
v_pk_add_u16 v41, v40, s25 op_sel_hi:[0,1]
v_pk_ashrrev_i16 v38, 15, v41 op_sel_hi:[0,1]
s_mov_b32 s25, 0x160015
v_pk_add_u16 v41, v40, s25 op_sel_hi:[0,1]
v_pk_ashrrev_i16 v39, 15, v41 op_sel_hi:[0,1]
v_lshrrev_b32 v41, 2, v2
v_lshrrev_b32 v40, 4, v2
v_xor_b32 v40, v40, v41
v_and_b32 v40, 1, v40
v_add_u32 v40, -1, v40
v_and_b32 v40, 0x3f803f80, v40
v_accvgpr_write_b32 a208, v40
v_bfe_u32 v40, v2, 2, 2
s_mul_i32 s68, s23, 49152
v_lshlrev_b32 v40, 3, v40
s_lshl_b32 s69, s29, 13
v_bfe_u32 v41, v2, 4, 1
s_add_u32 s68, s68, s69
v_lshl_add_u32 v40, v41, 2, v40
v_and_b32 v42, 3, v2
v_add_u32 v40, v40, v42
v_lshl_add_u32 v40, v5, 5, v40
v_lshlrev_b32 v40, 4, v40
v_add_u32 v4, s68, v40
v_lshrrev_b32 v40, 3, v2
v_mul_u32_u24 v40, 12544, v40
v_and_b32 v56, 7, v2
v_lshl_add_u32 v57, v56, 4, v40
v_accvgpr_write_b32 a209, v57
v_add_u32 v57, v57, v40
v_accvgpr_write_b32 a210, v57
v_lshlrev_b32 v40, 2, v41
v_lshl_add_u32 v40, v56, 4, v40
v_lshl_add_u32 v8, v5, 1, v40
s_lshl_b32 s69, s21, 1
s_sub_u32 s69, s69, 4
v_add_u32 v57, s69, v42
v_max_i32 v57, 0, v57
v_lshlrev_b32 v42, 2, v57
v_and_b32 v52, 15, v2
v_cmp_eq_u32 vcc, 0, v52
v_lshrrev_b32 v30, 4, v2
v_lshlrev_b32 v30, 5, v30
v_cndmask_b32 v53, v7, v30, vcc
v_lshlrev_b32 v40, 4, v52
v_lshl_add_u32 v40, v5, 9, v40
v_lshl_add_u32 v40, v41, 10, v40
s_add_u32 s68, s68, 32768
v_accvgpr_write_b32 a211, v40
v_add_u32 v54, s68, v40
v_lshrrev_b32 v52, 1, v52
s_lshl_b32 s69, s29, 2
v_lshlrev_b32 v52, 7, v52
v_and_b32 v41, 1, v2
v_lshl_add_u32 v52, v41, 3, v52
v_add_u32 v52, s69, v52
v_accvgpr_write_b32 a212, v52
v_and_b32 v40, 31, v2
v_lshlrev_b32 v55, 3, v40
s_lshl_b32 s25, s29, 5
s_add_u32 s25, s25, s36
s_and_b32 s68, s25, 7
s_lshl_b32 s25, s25, 8
v_bfe_u32 v48, v2, 2, 3
v_xor_b32 v48, s68, v48
v_lshlrev_b32 v48, 4, v48
v_lshl_add_u32 v48, v5, 7, v48
v_and_b32 v49, 3, v2
v_lshl_add_u32 v48, v49, 2, v48
v_add_u32 v48, s25, v48
v_and_b32 v6, 31, v2
v_cmp_eq_u32 vcc, 31, v6
v_lshlrev_b32 v6, 2, v6
v_add_u32 v49, 131072, v6
v_lshlrev_b32 v46, 3, v5
v_cndmask_b32 v46, v7, v46, vcc
v_mov_b32 v45, 1
s_add_u32 m0, s28, 24576
s_nop 0
buffer_load_dwordx4 v14, s[12:15], s31 offen offset:0  lds
buffer_load_dwordx4 v15, s[12:15], s31 offen offset:1024  lds
buffer_load_dwordx4 v16, s[12:15], s31 offen offset:2048  lds
s_add_u32 m0, s28, 27648
s_nop 0
buffer_load_dwordx4 v17, s[12:15], s31 offen offset:0  lds
buffer_load_dwordx4 v18, s[12:15], s31 offen offset:1024  lds
buffer_load_dwordx4 v19, s[12:15], s31 offen offset:2048  lds
s_add_u32 s31, s31, 393216
s_waitcnt vmcnt(9)
s_barrier
s_add_u32 m0, s27, 16384
ds_read_b128 a[0:3], v20 offset:0
buffer_load_dwordx4 v10, s[8:11], s30 offen offset:0  lds
ds_read_b128 a[4:7], v21 offset:0
ds_read_b128 a[8:11], v20 offset:2048
ds_read_b128 a[12:15], v21 offset:2048
ds_read_b128 a[16:19], v20 offset:4096
ds_read_b128 a[20:23], v21 offset:4096
ds_read_b128 a[24:27], v20 offset:6144
ds_read_b128 a[28:31], v21 offset:6144
ds_read_b64_tr_b16 a[80:81], v22 offset:1024
buffer_load_dwordx4 v11, s[8:11], s30 offen offset:1024  lds
ds_read_b64_tr_b16 a[82:83], v22 offset:1280
ds_read_b64_tr_b16 a[84:85], v22 offset:13312
ds_read_b64_tr_b16 a[86:87], v22 offset:13568
ds_read_b64_tr_b16 a[88:89], v23 offset:1024
ds_read_b64_tr_b16 a[90:91], v23 offset:1280
ds_read_b64_tr_b16 a[92:93], v23 offset:13312
ds_read_b64_tr_b16 a[94:95], v23 offset:13568
ds_read_b64_tr_b16 a[96:97], v22 offset:2048
buffer_load_dwordx4 v12, s[8:11], s30 offen offset:2048  lds
ds_read_b64_tr_b16 a[98:99], v22 offset:2304
ds_read_b64_tr_b16 a[100:101], v22 offset:14336
ds_read_b64_tr_b16 a[102:103], v22 offset:14592
ds_read_b64_tr_b16 a[104:105], v23 offset:2048
ds_read_b64_tr_b16 a[106:107], v23 offset:2304
ds_read_b64_tr_b16 a[108:109], v23 offset:14336
ds_read_b64_tr_b16 a[110:111], v23 offset:14592
ds_read_b64_tr_b16 a[64:65], v22 offset:0
buffer_load_dwordx4 v13, s[8:11], s30 offen offset:3072  lds
s_add_u32 s30, s30, 128
ds_read_b64_tr_b16 a[66:67], v22 offset:256
ds_read_b64_tr_b16 a[68:69], v22 offset:12288
ds_read_b64_tr_b16 a[70:71], v22 offset:12544
ds_read_b64_tr_b16 a[72:73], v23 offset:0
ds_read_b64_tr_b16 a[74:75], v23 offset:256
ds_read_b64_tr_b16 a[76:77], v23 offset:12288
ds_read_b64_tr_b16 a[78:79], v23 offset:12544
s_waitcnt lgkmcnt(0)
v_mfma_f32_16x16x32_bf16 v[192:195], a[80:83], a[0:3], 0
s_add_u32 m0, s28, 49152
v_mfma_f32_16x16x32_bf16 v[192:195], a[84:87], a[4:7], v[192:195]
buffer_load_dwordx4 v14, s[40:43], s31 offen offset:0  lds
v_mfma_f32_16x16x32_bf16 v[200:203], a[84:87], a[12:15], 0
ds_read_b32 v43, v48 offset:0
v_mfma_f32_16x16x32_bf16 v[200:203], a[80:83], a[8:11], v[200:203]
v_mfma_f32_16x16x32_bf16 v[208:211], a[80:83], a[16:19], 0
v_mfma_f32_16x16x32_bf16 v[208:211], a[84:87], a[20:23], v[208:211]
buffer_load_dwordx4 v15, s[40:43], s31 offen offset:1024  lds
v_mfma_f32_16x16x32_bf16 v[216:219], a[84:87], a[28:31], 0
v_mfma_f32_16x16x32_bf16 v[216:219], a[80:83], a[24:27], v[216:219]
v_mfma_f32_16x16x32_bf16 v[220:223], a[88:91], a[24:27], 0
v_mfma_f32_16x16x32_bf16 v[220:223], a[92:95], a[28:31], v[220:223]
buffer_load_dwordx4 v16, s[40:43], s31 offen offset:2048  lds
v_mfma_f32_16x16x32_bf16 v[212:215], a[92:95], a[20:23], 0
v_mfma_f32_16x16x32_bf16 v[212:215], a[88:91], a[16:19], v[212:215]
v_mfma_f32_16x16x32_bf16 v[204:207], a[88:91], a[8:11], 0
s_waitcnt vmcnt(7)
s_barrier
s_add_u32 m0, s28, 52224
v_mfma_f32_16x16x32_bf16 v[204:207], a[92:95], a[12:15], v[204:207]
buffer_load_dwordx4 v17, s[40:43], s31 offen offset:0  lds
v_mfma_f32_16x16x32_bf16 v[196:199], a[92:95], a[4:7], 0
ds_read_b64_tr_b16 a[128:129], v22 offset:25600
v_mfma_f32_16x16x32_bf16 v[196:199], a[88:91], a[0:3], v[196:199]
ds_read_b64_tr_b16 a[130:131], v22 offset:25856
v_mfma_f32_16x16x32_bf16 v[224:227], a[0:3], a[96:99], 0
ds_read_b64_tr_b16 a[132:133], v22 offset:37888
v_mfma_f32_16x16x32_bf16 v[224:227], a[4:7], a[100:103], v[224:227]
buffer_load_dwordx4 v18, s[40:43], s31 offen offset:1024  lds
v_mfma_f32_16x16x32_bf16 v[228:231], a[12:15], a[100:103], 0
ds_read_b64_tr_b16 a[134:135], v22 offset:38144
v_mfma_f32_16x16x32_bf16 v[228:231], a[8:11], a[96:99], v[228:231]
ds_read_b64_tr_b16 a[136:137], v23 offset:25600
v_mfma_f32_16x16x32_bf16 v[240:243], a[16:19], a[96:99], 0
ds_read_b64_tr_b16 a[138:139], v23 offset:25856
v_mfma_f32_16x16x32_bf16 v[240:243], a[20:23], a[100:103], v[240:243]
buffer_load_dwordx4 v19, s[40:43], s31 offen offset:2048  lds
v_mfma_f32_16x16x32_bf16 v[244:247], a[28:31], a[100:103], 0
ds_read_b64_tr_b16 a[140:141], v23 offset:37888
v_mfma_f32_16x16x32_bf16 v[244:247], a[24:27], a[96:99], v[244:247]
ds_read_b64_tr_b16 a[142:143], v23 offset:38144
v_mfma_f32_16x16x32_bf16 v[252:255], a[24:27], a[104:107], 0
s_add_u32 m0, s28, 73728
ds_read_b64_tr_b16 a[144:145], v22 offset:26624
v_mfma_f32_16x16x32_bf16 v[252:255], a[28:31], a[108:111], v[252:255]
buffer_load_dwordx4 v14, s[12:15], s31 offen offset:0  lds
v_mfma_f32_16x16x32_bf16 v[248:251], a[20:23], a[108:111], 0
ds_read_b64_tr_b16 a[146:147], v22 offset:26880
v_mfma_f32_16x16x32_bf16 v[248:251], a[16:19], a[104:107], v[248:251]
ds_read_b64_tr_b16 a[148:149], v22 offset:38912
v_mfma_f32_16x16x32_bf16 v[236:239], a[8:11], a[104:107], 0
ds_read_b64_tr_b16 a[150:151], v22 offset:39168
v_mfma_f32_16x16x32_bf16 v[236:239], a[12:15], a[108:111], v[236:239]
buffer_load_dwordx4 v15, s[12:15], s31 offen offset:1024  lds
v_mfma_f32_16x16x32_bf16 v[232:235], a[4:7], a[108:111], 0
ds_read_b64_tr_b16 a[152:153], v23 offset:26624
v_mfma_f32_16x16x32_bf16 v[232:235], a[0:3], a[104:107], v[232:235]
ds_read_b64_tr_b16 a[154:155], v23 offset:26880
v_mfma_f32_16x16x32_bf16 v[160:163], a[64:67], a[0:3], 0
ds_read_b64_tr_b16 a[156:157], v23 offset:38912
v_mfma_f32_16x16x32_bf16 v[160:163], a[68:71], a[4:7], v[160:163]
buffer_load_dwordx4 v16, s[12:15], s31 offen offset:2048  lds
v_mfma_f32_16x16x32_bf16 v[168:171], a[68:71], a[12:15], 0
ds_read_b64_tr_b16 a[158:159], v23 offset:39168
v_mfma_f32_16x16x32_bf16 v[168:171], a[64:67], a[8:11], v[168:171]
ds_read_b64_tr_b16 a[112:113], v22 offset:24576
v_mfma_f32_16x16x32_bf16 v[176:179], a[64:67], a[16:19], 0
s_add_u32 m0, s28, 76800
ds_read_b64_tr_b16 a[114:115], v22 offset:24832
v_mfma_f32_16x16x32_bf16 v[176:179], a[68:71], a[20:23], v[176:179]
buffer_load_dwordx4 v17, s[12:15], s31 offen offset:0  lds
v_mfma_f32_16x16x32_bf16 v[184:187], a[68:71], a[28:31], 0
ds_read_b64_tr_b16 a[116:117], v22 offset:36864
v_mfma_f32_16x16x32_bf16 v[184:187], a[64:67], a[24:27], v[184:187]
ds_read_b64_tr_b16 a[118:119], v22 offset:37120
v_mfma_f32_16x16x32_bf16 v[188:191], a[72:75], a[24:27], 0
ds_read_b64_tr_b16 a[120:121], v23 offset:24576
v_mfma_f32_16x16x32_bf16 v[188:191], a[76:79], a[28:31], v[188:191]
buffer_load_dwordx4 v18, s[12:15], s31 offen offset:1024  lds
v_mfma_f32_16x16x32_bf16 v[180:183], a[76:79], a[20:23], 0
ds_read_b64_tr_b16 a[122:123], v23 offset:24832
v_mfma_f32_16x16x32_bf16 v[180:183], a[72:75], a[16:19], v[180:183]
ds_read_b64_tr_b16 a[124:125], v23 offset:36864
ds_read_b64_tr_b16 a[126:127], v23 offset:37120
v_mfma_f32_16x16x32_bf16 v[172:175], a[72:75], a[8:11], 0
v_mfma_f32_16x16x32_bf16 v[172:175], a[76:79], a[12:15], v[172:175]
buffer_load_dwordx4 v19, s[12:15], s31 offen offset:2048  lds
s_add_u32 s31, s31, 393216
v_mfma_f32_16x16x32_bf16 v[164:167], a[76:79], a[4:7], 0
s_waitcnt vmcnt(6) lgkmcnt(0)
s_barrier
v_mfma_f32_16x16x32_bf16 v[164:167], a[72:75], a[0:3], v[164:167]
ds_read_b32 v44, v49
v_mfma_f32_16x16x32_bf16 v[96:99], a[0:3], a[128:131], v[68:71]
s_add_u32 m0, s28, 0
ds_read_b32 v50, v48 offset:16384
v_mfma_f32_16x16x32_bf16 v[96:99], a[4:7], a[132:135], v[96:99]
buffer_load_dwordx4 v14, s[40:43], s31 offen offset:0  lds
v_mfma_f32_16x16x32_bf16 v[100:103], a[12:15], a[132:135], v[68:71]
buffer_load_dword v0, v26, s[4:7], s3 offen
s_add_u32 s3, s3, s37
v_mfma_f32_16x16x32_bf16 v[100:103], a[8:11], a[128:131], v[100:103]
ds_read_b32 v51, v49 offset:128
v_mfma_f32_16x16x32_bf16 v[112:115], a[16:19], a[128:131], v[68:71]
ds_read_b128 a[32:35], v20 offset:16384
v_mfma_f32_16x16x32_bf16 v[112:115], a[20:23], a[132:135], v[112:115]
buffer_load_dwordx4 v15, s[40:43], s31 offen offset:1024  lds
v_mfma_f32_16x16x32_bf16 v[116:119], a[28:31], a[132:135], v[68:71]
ds_read_b128 a[36:39], v21 offset:16384
v_mfma_f32_16x16x32_bf16 v[116:119], a[24:27], a[128:131], v[116:119]
ds_read_b128 a[40:43], v20 offset:18432
v_mfma_f32_16x16x32_bf16 v[124:127], a[24:27], a[136:139], v[68:71]
ds_read_b128 a[44:47], v21 offset:18432
v_mfma_f32_16x16x32_bf16 v[124:127], a[28:31], a[140:143], v[124:127]
buffer_load_dwordx4 v16, s[40:43], s31 offen offset:2048  lds
v_mfma_f32_16x16x32_bf16 v[120:123], a[20:23], a[140:143], v[68:71]
ds_read_b128 a[48:51], v20 offset:20480
v_mfma_f32_16x16x32_bf16 v[120:123], a[16:19], a[136:139], v[120:123]
ds_read_b128 a[52:55], v21 offset:20480
v_mfma_f32_16x16x32_bf16 v[108:111], a[8:11], a[136:139], v[68:71]
s_add_u32 m0, s28, 3072
ds_read_b128 a[56:59], v20 offset:22528
v_mfma_f32_16x16x32_bf16 v[108:111], a[12:15], a[140:143], v[108:111]
buffer_load_dwordx4 v17, s[40:43], s31 offen offset:0  lds
v_mfma_f32_16x16x32_bf16 v[104:107], a[4:7], a[140:143], v[68:71]
ds_read_b128 a[60:63], v21 offset:22528
v_mfma_f32_16x16x32_bf16 v[104:107], a[0:3], a[136:139], v[104:107]
ds_read_b64_tr_b16 a[80:81], v24 offset:1024
v_mfma_f32_16x16x32_bf16 v[128:131], a[0:3], a[144:147], 0
ds_read_b64_tr_b16 a[82:83], v24 offset:1280
v_mfma_f32_16x16x32_bf16 v[128:131], a[4:7], a[148:151], v[128:131]
buffer_load_dwordx4 v18, s[40:43], s31 offen offset:1024  lds
v_mfma_f32_16x16x32_bf16 v[132:135], a[12:15], a[148:151], 0
ds_read_b64_tr_b16 a[84:85], v24 offset:13312
v_mfma_f32_16x16x32_bf16 v[132:135], a[8:11], a[144:147], v[132:135]
ds_read_b64_tr_b16 a[86:87], v24 offset:13568
v_mfma_f32_16x16x32_bf16 v[144:147], a[16:19], a[144:147], 0
ds_read_b64_tr_b16 a[88:89], v25 offset:1024
v_mfma_f32_16x16x32_bf16 v[144:147], a[20:23], a[148:151], v[144:147]
buffer_load_dwordx4 v19, s[40:43], s31 offen offset:2048  lds
v_mfma_f32_16x16x32_bf16 v[148:151], a[28:31], a[148:151], 0
ds_read_b64_tr_b16 a[90:91], v25 offset:1280
v_mfma_f32_16x16x32_bf16 v[148:151], a[24:27], a[144:147], v[148:151]
ds_read_b64_tr_b16 a[92:93], v25 offset:13312
v_mfma_f32_16x16x32_bf16 v[156:159], a[24:27], a[152:155], 0
s_add_u32 m0, s27, 0
ds_read_b64_tr_b16 a[94:95], v25 offset:13568
v_mfma_f32_16x16x32_bf16 v[156:159], a[28:31], a[156:159], v[156:159]
buffer_load_dwordx4 v10, s[8:11], s30 offen offset:0  lds
v_mfma_f32_16x16x32_bf16 v[152:155], a[20:23], a[156:159], 0
ds_read_b64_tr_b16 a[96:97], v24 offset:2048
v_mfma_f32_16x16x32_bf16 v[152:155], a[16:19], a[152:155], v[152:155]
ds_read_b64_tr_b16 a[98:99], v24 offset:2304
v_mfma_f32_16x16x32_bf16 v[140:143], a[8:11], a[152:155], 0
ds_read_b64_tr_b16 a[100:101], v24 offset:14336
v_mfma_f32_16x16x32_bf16 v[140:143], a[12:15], a[156:159], v[140:143]
buffer_load_dwordx4 v11, s[8:11], s30 offen offset:1024  lds
v_mfma_f32_16x16x32_bf16 v[136:139], a[4:7], a[156:159], 0
ds_read_b64_tr_b16 a[102:103], v24 offset:14592
v_mfma_f32_16x16x32_bf16 v[136:139], a[0:3], a[152:155], v[136:139]
ds_read_b64_tr_b16 a[104:105], v25 offset:2048
v_mfma_f32_16x16x32_bf16 v[64:67], a[112:115], a[0:3], v[68:71]
ds_read_b64_tr_b16 a[106:107], v25 offset:2304
v_mfma_f32_16x16x32_bf16 v[64:67], a[116:119], a[4:7], v[64:67]
buffer_load_dwordx4 v12, s[8:11], s30 offen offset:2048  lds
v_mfma_f32_16x16x32_bf16 v[72:75], a[116:119], a[12:15], v[68:71]
ds_read_b64_tr_b16 a[108:109], v25 offset:14336
v_mfma_f32_16x16x32_bf16 v[72:75], a[112:115], a[8:11], v[72:75]
ds_read_b64_tr_b16 a[110:111], v25 offset:14592
v_mfma_f32_16x16x32_bf16 v[80:83], a[112:115], a[16:19], v[68:71]
ds_read_b64_tr_b16 a[64:65], v24 offset:0
ds_read_b64_tr_b16 a[66:67], v24 offset:256
ds_read_b64_tr_b16 a[68:69], v24 offset:12288
ds_read_b64_tr_b16 a[70:71], v24 offset:12544
ds_read_b64_tr_b16 a[72:73], v25 offset:0
ds_read_b64_tr_b16 a[74:75], v25 offset:256
ds_read_b64_tr_b16 a[76:77], v25 offset:12288
ds_read_b64_tr_b16 a[78:79], v25 offset:12544
v_mfma_f32_16x16x32_bf16 v[80:83], a[116:119], a[20:23], v[80:83]
buffer_load_dwordx4 v13, s[8:11], s30 offen offset:3072  lds
s_add_u32 s30, s30, 128
v_mfma_f32_16x16x32_bf16 v[88:91], a[116:119], a[28:31], v[68:71]
v_mfma_f32_16x16x32_bf16 v[88:91], a[112:115], a[24:27], v[88:91]
s_waitcnt vmcnt(11) lgkmcnt(0)
s_barrier
v_mfma_f32_16x16x32_bf16 v[92:95], a[120:123], a[24:27], v[68:71]
s_add_u32 m0, s28, 24576
v_lshlrev_b32 v52, 16, v43
v_lshlrev_b32 v47, 16, v44
v_mfma_f32_16x16x32_bf16 v[92:95], a[124:127], a[28:31], v[92:95]
buffer_load_dwordx4 v14, s[12:15], s31 offen offset:0  lds
v_mfma_f32_16x16x32_bf16 v[84:87], a[124:127], a[20:23], v[68:71]
v_and_b32 v43, 0xffff0000, v43
v_fmac_f32 v1, v52, v47
v_mfma_f32_16x16x32_bf16 v[84:87], a[120:123], a[16:19], v[84:87]
v_and_b32 v47, 0xffff0000, v44
v_fmac_f32 v1, v43, v47
v_mfma_f32_16x16x32_bf16 v[76:79], a[120:123], a[8:11], v[68:71]
v_lshlrev_b32 v52, 16, v50
v_lshlrev_b32 v47, 16, v51
v_mfma_f32_16x16x32_bf16 v[76:79], a[124:127], a[12:15], v[76:79]
buffer_load_dwordx4 v15, s[12:15], s31 offen offset:1024  lds
v_mfma_f32_16x16x32_bf16 v[68:71], a[124:127], a[4:7], v[68:71]
v_and_b32 v50, 0xffff0000, v50
v_fmac_f32 v1, v52, v47
v_mfma_f32_16x16x32_bf16 v[68:71], a[120:123], a[0:3], v[68:71]
v_and_b32 v47, 0xffff0000, v51
v_fmac_f32 v1, v50, v47
v_mfma_f32_16x16x32_bf16 v[192:195], a[80:83], a[32:35], v[192:195]
ds_read_b64_tr_b16 a[128:129], v24 offset:25600
v_add_u32 v49, 128, v49
v_mfma_f32_16x16x32_bf16 v[192:195], a[84:87], a[36:39], v[192:195]
buffer_load_dwordx4 v16, s[12:15], s31 offen offset:2048  lds
v_mfma_f32_16x16x32_bf16 v[200:203], a[84:87], a[44:47], v[200:203]
ds_read_b64_tr_b16 a[130:131], v24 offset:25856
v_mfma_f32_16x16x32_bf16 v[200:203], a[80:83], a[40:43], v[200:203]
ds_read_b64_tr_b16 a[132:133], v24 offset:37888
v_mfma_f32_16x16x32_bf16 v[208:211], a[80:83], a[48:51], v[208:211]
s_add_u32 m0, s28, 27648
ds_read_b64_tr_b16 a[134:135], v24 offset:38144
v_mfma_f32_16x16x32_bf16 v[208:211], a[84:87], a[52:55], v[208:211]
buffer_load_dwordx4 v17, s[12:15], s31 offen offset:0  lds
v_mfma_f32_16x16x32_bf16 v[216:219], a[84:87], a[60:63], v[216:219]
ds_read_b64_tr_b16 a[136:137], v25 offset:25600
v_mfma_f32_16x16x32_bf16 v[216:219], a[80:83], a[56:59], v[216:219]
ds_read_b64_tr_b16 a[138:139], v25 offset:25856
v_mfma_f32_16x16x32_bf16 v[220:223], a[88:91], a[56:59], v[220:223]
ds_read_b64_tr_b16 a[140:141], v25 offset:37888
v_mfma_f32_16x16x32_bf16 v[220:223], a[92:95], a[60:63], v[220:223]
buffer_load_dwordx4 v18, s[12:15], s31 offen offset:1024  lds
v_mfma_f32_16x16x32_bf16 v[212:215], a[92:95], a[52:55], v[212:215]
ds_read_b64_tr_b16 a[142:143], v25 offset:38144
v_mfma_f32_16x16x32_bf16 v[212:215], a[88:91], a[48:51], v[212:215]
ds_read_b64_tr_b16 a[144:145], v24 offset:26624
v_mfma_f32_16x16x32_bf16 v[204:207], a[88:91], a[40:43], v[204:207]
ds_read_b64_tr_b16 a[146:147], v24 offset:26880
v_mfma_f32_16x16x32_bf16 v[204:207], a[92:95], a[44:47], v[204:207]
buffer_load_dwordx4 v19, s[12:15], s31 offen offset:2048  lds
s_add_u32 s31, s31, 393216
v_mfma_f32_16x16x32_bf16 v[196:199], a[92:95], a[36:39], v[196:199]
buffer_load_dword v0, v26, s[4:7], s3 offen
s_add_u32 s3, s3, s37
v_mfma_f32_16x16x32_bf16 v[196:199], a[88:91], a[32:35], v[196:199]
buffer_load_dword v0, v26, s[4:7], s3 offen
s_add_u32 s3, s3, s37
v_mfma_f32_16x16x32_bf16 v[224:227], a[32:35], a[96:99], v[224:227]
s_add_u32 m0, s28, 49152
ds_read_b64_tr_b16 a[148:149], v24 offset:38912
v_mfma_f32_16x16x32_bf16 v[224:227], a[36:39], a[100:103], v[224:227]
buffer_load_dwordx4 v14, s[40:43], s31 offen offset:0  lds
v_mfma_f32_16x16x32_bf16 v[228:231], a[44:47], a[100:103], v[228:231]
ds_read_b64_tr_b16 a[150:151], v24 offset:39168
v_mfma_f32_16x16x32_bf16 v[228:231], a[40:43], a[96:99], v[228:231]
ds_read_b64_tr_b16 a[152:153], v25 offset:26624
v_mfma_f32_16x16x32_bf16 v[240:243], a[48:51], a[96:99], v[240:243]
ds_read_b64_tr_b16 a[154:155], v25 offset:26880
v_mfma_f32_16x16x32_bf16 v[240:243], a[52:55], a[100:103], v[240:243]
buffer_load_dwordx4 v15, s[40:43], s31 offen offset:1024  lds
v_mfma_f32_16x16x32_bf16 v[244:247], a[60:63], a[100:103], v[244:247]
ds_read_b64_tr_b16 a[156:157], v25 offset:38912
v_mfma_f32_16x16x32_bf16 v[244:247], a[56:59], a[96:99], v[244:247]
ds_read_b64_tr_b16 a[158:159], v25 offset:39168
v_mfma_f32_16x16x32_bf16 v[252:255], a[56:59], a[104:107], v[252:255]
ds_read_b64_tr_b16 a[112:113], v24 offset:24576
v_mfma_f32_16x16x32_bf16 v[252:255], a[60:63], a[108:111], v[252:255]
buffer_load_dwordx4 v16, s[40:43], s31 offen offset:2048  lds
v_mfma_f32_16x16x32_bf16 v[248:251], a[52:55], a[108:111], v[248:251]
ds_read_b64_tr_b16 a[114:115], v24 offset:24832
v_mfma_f32_16x16x32_bf16 v[248:251], a[48:51], a[104:107], v[248:251]
ds_read_b64_tr_b16 a[116:117], v24 offset:36864
v_mfma_f32_16x16x32_bf16 v[236:239], a[40:43], a[104:107], v[236:239]
s_add_u32 m0, s28, 52224
ds_read_b64_tr_b16 a[118:119], v24 offset:37120
v_mfma_f32_16x16x32_bf16 v[236:239], a[44:47], a[108:111], v[236:239]
buffer_load_dwordx4 v17, s[40:43], s31 offen offset:0  lds
v_mfma_f32_16x16x32_bf16 v[232:235], a[36:39], a[108:111], v[232:235]
ds_read_b64_tr_b16 a[120:121], v25 offset:24576
v_mfma_f32_16x16x32_bf16 v[232:235], a[32:35], a[104:107], v[232:235]
ds_read_b64_tr_b16 a[122:123], v25 offset:24832
v_mfma_f32_16x16x32_bf16 v[160:163], a[64:67], a[32:35], v[160:163]
ds_read_b64_tr_b16 a[124:125], v25 offset:36864
v_mfma_f32_16x16x32_bf16 v[160:163], a[68:71], a[36:39], v[160:163]
buffer_load_dwordx4 v18, s[40:43], s31 offen offset:1024  lds
v_mfma_f32_16x16x32_bf16 v[168:171], a[68:71], a[44:47], v[168:171]
ds_read_b64_tr_b16 a[126:127], v25 offset:37120
v_mfma_f32_16x16x32_bf16 v[168:171], a[64:67], a[40:43], v[168:171]
v_mfma_f32_16x16x32_bf16 v[176:179], a[64:67], a[48:51], v[176:179]
v_mfma_f32_16x16x32_bf16 v[176:179], a[68:71], a[52:55], v[176:179]
buffer_load_dwordx4 v19, s[40:43], s31 offen offset:2048  lds
v_mfma_f32_16x16x32_bf16 v[184:187], a[68:71], a[60:63], v[184:187]
v_mfma_f32_16x16x32_bf16 v[184:187], a[64:67], a[56:59], v[184:187]
s_waitcnt vmcnt(14) lgkmcnt(0)
s_barrier
v_mfma_f32_16x16x32_bf16 v[188:191], a[72:75], a[56:59], v[188:191]
s_add_u32 m0, s27, 16384
ds_read_b32 v50, v48 offset:0
v_mfma_f32_16x16x32_bf16 v[188:191], a[76:79], a[60:63], v[188:191]
buffer_load_dwordx4 v10, s[8:11], s30 offen offset:0  lds
v_mfma_f32_16x16x32_bf16 v[180:183], a[76:79], a[52:55], v[180:183]
ds_read_b32 v51, v49 offset:128
v_mfma_f32_16x16x32_bf16 v[180:183], a[72:75], a[48:51], v[180:183]
ds_read_b128 a[0:3], v20 offset:0
v_mfma_f32_16x16x32_bf16 v[172:175], a[72:75], a[40:43], v[172:175]
ds_read_b128 a[4:7], v21 offset:0
v_mfma_f32_16x16x32_bf16 v[172:175], a[76:79], a[44:47], v[172:175]
ds_read_b128 a[8:11], v20 offset:2048
v_mfma_f32_16x16x32_bf16 v[164:167], a[76:79], a[36:39], v[164:167]
buffer_load_dwordx4 v11, s[8:11], s30 offen offset:1024  lds
v_mfma_f32_16x16x32_bf16 v[164:167], a[72:75], a[32:35], v[164:167]
ds_read_b128 a[12:15], v21 offset:2048
v_mfma_f32_16x16x32_bf16 v[96:99], a[32:35], a[128:131], v[96:99]
ds_read_b128 a[16:19], v20 offset:4096
v_mfma_f32_16x16x32_bf16 v[96:99], a[36:39], a[132:135], v[96:99]
ds_read_b128 a[20:23], v21 offset:4096
v_mfma_f32_16x16x32_bf16 v[100:103], a[44:47], a[132:135], v[100:103]
ds_read_b128 a[24:27], v20 offset:6144
v_mfma_f32_16x16x32_bf16 v[100:103], a[40:43], a[128:131], v[100:103]
ds_read_b128 a[28:31], v21 offset:6144
v_mfma_f32_16x16x32_bf16 v[112:115], a[48:51], a[128:131], v[112:115]
buffer_load_dwordx4 v12, s[8:11], s30 offen offset:2048  lds
v_mfma_f32_16x16x32_bf16 v[112:115], a[52:55], a[132:135], v[112:115]
ds_read_b64_tr_b16 a[80:81], v22 offset:1024
v_mfma_f32_16x16x32_bf16 v[116:119], a[60:63], a[132:135], v[116:119]
ds_read_b64_tr_b16 a[82:83], v22 offset:1280
v_mfma_f32_16x16x32_bf16 v[116:119], a[56:59], a[128:131], v[116:119]
ds_read_b64_tr_b16 a[84:85], v22 offset:13312
v_mfma_f32_16x16x32_bf16 v[124:127], a[56:59], a[136:139], v[124:127]
ds_read_b64_tr_b16 a[86:87], v22 offset:13568
v_mfma_f32_16x16x32_bf16 v[124:127], a[60:63], a[140:143], v[124:127]
ds_read_b64_tr_b16 a[88:89], v23 offset:1024
v_mfma_f32_16x16x32_bf16 v[120:123], a[52:55], a[140:143], v[120:123]
buffer_load_dwordx4 v13, s[8:11], s30 offen offset:3072  lds
s_add_u32 s30, s30, 128
v_mfma_f32_16x16x32_bf16 v[120:123], a[48:51], a[136:139], v[120:123]
ds_read_b64_tr_b16 a[90:91], v23 offset:1280
v_mfma_f32_16x16x32_bf16 v[108:111], a[40:43], a[136:139], v[108:111]
ds_read_b64_tr_b16 a[92:93], v23 offset:13312
v_mfma_f32_16x16x32_bf16 v[108:111], a[44:47], a[140:143], v[108:111]
ds_read_b64_tr_b16 a[94:95], v23 offset:13568
v_mfma_f32_16x16x32_bf16 v[104:107], a[36:39], a[140:143], v[104:107]
ds_read_b64_tr_b16 a[96:97], v22 offset:2048
v_mfma_f32_16x16x32_bf16 v[104:107], a[32:35], a[136:139], v[104:107]
s_add_u32 m0, s28, 73728
ds_read_b64_tr_b16 a[98:99], v22 offset:2304
v_mfma_f32_16x16x32_bf16 v[128:131], a[32:35], a[144:147], v[128:131]
buffer_load_dwordx4 v14, s[12:15], s31 offen offset:0  lds
v_mfma_f32_16x16x32_bf16 v[128:131], a[36:39], a[148:151], v[128:131]
ds_read_b64_tr_b16 a[100:101], v22 offset:14336
v_mfma_f32_16x16x32_bf16 v[132:135], a[44:47], a[148:151], v[132:135]
ds_read_b64_tr_b16 a[102:103], v22 offset:14592
v_mfma_f32_16x16x32_bf16 v[132:135], a[40:43], a[144:147], v[132:135]
ds_read_b64_tr_b16 a[104:105], v23 offset:2048
v_mfma_f32_16x16x32_bf16 v[144:147], a[48:51], a[144:147], v[144:147]
ds_read_b64_tr_b16 a[106:107], v23 offset:2304
v_mfma_f32_16x16x32_bf16 v[144:147], a[52:55], a[148:151], v[144:147]
ds_read_b64_tr_b16 a[108:109], v23 offset:14336
v_mfma_f32_16x16x32_bf16 v[148:151], a[60:63], a[148:151], v[148:151]
buffer_load_dwordx4 v15, s[12:15], s31 offen offset:1024  lds
v_mfma_f32_16x16x32_bf16 v[148:151], a[56:59], a[144:147], v[148:151]
ds_read_b64_tr_b16 a[110:111], v23 offset:14592
v_mfma_f32_16x16x32_bf16 v[156:159], a[56:59], a[152:155], v[156:159]
ds_read_b64_tr_b16 a[64:65], v22 offset:0
v_mfma_f32_16x16x32_bf16 v[156:159], a[60:63], a[156:159], v[156:159]
ds_read_b64_tr_b16 a[66:67], v22 offset:256
v_mfma_f32_16x16x32_bf16 v[152:155], a[52:55], a[156:159], v[152:155]
ds_read_b64_tr_b16 a[68:69], v22 offset:12288
v_mfma_f32_16x16x32_bf16 v[152:155], a[48:51], a[152:155], v[152:155]
ds_read_b64_tr_b16 a[70:71], v22 offset:12544
v_mfma_f32_16x16x32_bf16 v[140:143], a[40:43], a[152:155], v[140:143]
buffer_load_dwordx4 v16, s[12:15], s31 offen offset:2048  lds
v_mfma_f32_16x16x32_bf16 v[140:143], a[44:47], a[156:159], v[140:143]
ds_read_b64_tr_b16 a[72:73], v23 offset:0
v_mfma_f32_16x16x32_bf16 v[136:139], a[36:39], a[156:159], v[136:139]
ds_read_b64_tr_b16 a[74:75], v23 offset:256
v_mfma_f32_16x16x32_bf16 v[136:139], a[32:35], a[152:155], v[136:139]
ds_read_b64_tr_b16 a[76:77], v23 offset:12288
v_mfma_f32_16x16x32_bf16 v[64:67], a[112:115], a[32:35], v[64:67]
ds_read_b64_tr_b16 a[78:79], v23 offset:12544
v_mfma_f32_16x16x32_bf16 v[64:67], a[116:119], a[36:39], v[64:67]
s_add_u32 m0, s28, 76800
v_mfma_f32_16x16x32_bf16 v[72:75], a[116:119], a[44:47], v[72:75]
buffer_load_dwordx4 v17, s[12:15], s31 offen offset:0  lds
v_mfma_f32_16x16x32_bf16 v[72:75], a[112:115], a[40:43], v[72:75]
s_cmp_eq_u32 s24, 3
s_cselect_b32 s3, s62, s3
v_mfma_f32_16x16x32_bf16 v[80:83], a[112:115], a[48:51], v[80:83]
v_mfma_f32_16x16x32_bf16 v[80:83], a[116:119], a[52:55], v[80:83]
v_mfma_f32_16x16x32_bf16 v[88:91], a[116:119], a[60:63], v[88:91]
v_mfma_f32_16x16x32_bf16 v[88:91], a[112:115], a[56:59], v[88:91]
s_waitcnt vmcnt(16) lgkmcnt(0)
s_barrier
v_mfma_f32_16x16x32_bf16 v[92:95], a[120:123], a[56:59], v[92:95]
buffer_load_dwordx4 v18, s[12:15], s31 offen offset:1024  lds
v_mfma_f32_16x16x32_bf16 v[92:95], a[124:127], a[60:63], v[92:95]
v_lshlrev_b32 v52, 16, v50
v_lshlrev_b32 v47, 16, v51
v_mfma_f32_16x16x32_bf16 v[84:87], a[124:127], a[52:55], v[84:87]
v_and_b32 v50, 0xffff0000, v50
v_fmac_f32 v1, v52, v47
v_mfma_f32_16x16x32_bf16 v[84:87], a[120:123], a[48:51], v[84:87]
v_and_b32 v47, 0xffff0000, v51
v_fmac_f32 v1, v50, v47
v_mfma_f32_16x16x32_bf16 v[76:79], a[120:123], a[40:43], v[76:79]
v_add_u32 v49, 128, v49
v_mfma_f32_16x16x32_bf16 v[76:79], a[124:127], a[44:47], v[76:79]
v_mfma_f32_16x16x32_bf16 v[68:71], a[124:127], a[36:39], v[68:71]
buffer_load_dwordx4 v19, s[12:15], s31 offen offset:2048  lds
s_add_u32 s31, s31, 393216
v_mfma_f32_16x16x32_bf16 v[68:71], a[120:123], a[32:35], v[68:71]
s_mov_b32 s39, 5
.p2align 6
L_loop0_0:
v_mfma_f32_16x16x32_bf16 v[192:195], a[80:83], a[0:3], v[192:195]
buffer_load_dword v0, v26, s[4:7], s3 offen
s_add_u32 s3, s3, s37
v_mfma_f32_16x16x32_bf16 v[192:195], a[84:87], a[4:7], v[192:195]
ds_read_b64_tr_b16 a[128:129], v22 offset:25600
v_mfma_f32_16x16x32_bf16 v[200:203], a[84:87], a[12:15], v[200:203]
ds_read_b64_tr_b16 a[130:131], v22 offset:25856
v_mfma_f32_16x16x32_bf16 v[200:203], a[80:83], a[8:11], v[200:203]
s_add_u32 m0, s28, 0
ds_read_b64_tr_b16 a[132:133], v22 offset:37888
v_mfma_f32_16x16x32_bf16 v[208:211], a[80:83], a[16:19], v[208:211]
buffer_load_dwordx4 v14, s[40:43], s31 offen offset:0  lds
v_mfma_f32_16x16x32_bf16 v[208:211], a[84:87], a[20:23], v[208:211]
ds_read_b64_tr_b16 a[134:135], v22 offset:38144
v_mfma_f32_16x16x32_bf16 v[216:219], a[84:87], a[28:31], v[216:219]
ds_read_b64_tr_b16 a[136:137], v23 offset:25600
v_mfma_f32_16x16x32_bf16 v[216:219], a[80:83], a[24:27], v[216:219]
ds_read_b64_tr_b16 a[138:139], v23 offset:25856
v_mfma_f32_16x16x32_bf16 v[220:223], a[88:91], a[24:27], v[220:223]
ds_read_b64_tr_b16 a[140:141], v23 offset:37888
s_sub_u32 s39, s39, 1
v_mfma_f32_16x16x32_bf16 v[220:223], a[92:95], a[28:31], v[220:223]
ds_read_b64_tr_b16 a[142:143], v23 offset:38144
v_mfma_f32_16x16x32_bf16 v[212:215], a[92:95], a[20:23], v[212:215]
buffer_load_dwordx4 v15, s[40:43], s31 offen offset:1024  lds
v_mfma_f32_16x16x32_bf16 v[212:215], a[88:91], a[16:19], v[212:215]
ds_read_b64_tr_b16 a[144:145], v22 offset:26624
v_mfma_f32_16x16x32_bf16 v[204:207], a[88:91], a[8:11], v[204:207]
ds_read_b64_tr_b16 a[146:147], v22 offset:26880
v_mfma_f32_16x16x32_bf16 v[204:207], a[92:95], a[12:15], v[204:207]
ds_read_b64_tr_b16 a[148:149], v22 offset:38912
v_mfma_f32_16x16x32_bf16 v[196:199], a[92:95], a[4:7], v[196:199]
ds_read_b64_tr_b16 a[150:151], v22 offset:39168
v_mfma_f32_16x16x32_bf16 v[196:199], a[88:91], a[0:3], v[196:199]
ds_read_b64_tr_b16 a[152:153], v23 offset:26624
v_mfma_f32_16x16x32_bf16 v[224:227], a[0:3], a[96:99], v[224:227]
buffer_load_dwordx4 v16, s[40:43], s31 offen offset:2048  lds
v_mfma_f32_16x16x32_bf16 v[224:227], a[4:7], a[100:103], v[224:227]
ds_read_b64_tr_b16 a[154:155], v23 offset:26880
v_mfma_f32_16x16x32_bf16 v[228:231], a[12:15], a[100:103], v[228:231]
ds_read_b64_tr_b16 a[156:157], v23 offset:38912
v_mfma_f32_16x16x32_bf16 v[228:231], a[8:11], a[96:99], v[228:231]
ds_read_b64_tr_b16 a[158:159], v23 offset:39168
v_mfma_f32_16x16x32_bf16 v[240:243], a[16:19], a[96:99], v[240:243]
ds_read_b64_tr_b16 a[112:113], v22 offset:24576
v_mfma_f32_16x16x32_bf16 v[240:243], a[20:23], a[100:103], v[240:243]
s_add_u32 m0, s28, 3072
ds_read_b64_tr_b16 a[114:115], v22 offset:24832
v_mfma_f32_16x16x32_bf16 v[244:247], a[28:31], a[100:103], v[244:247]
buffer_load_dwordx4 v17, s[40:43], s31 offen offset:0  lds
v_mfma_f32_16x16x32_bf16 v[244:247], a[24:27], a[96:99], v[244:247]
ds_read_b64_tr_b16 a[116:117], v22 offset:36864
v_mfma_f32_16x16x32_bf16 v[252:255], a[24:27], a[104:107], v[252:255]
ds_read_b64_tr_b16 a[118:119], v22 offset:37120
v_mfma_f32_16x16x32_bf16 v[252:255], a[28:31], a[108:111], v[252:255]
ds_read_b64_tr_b16 a[120:121], v23 offset:24576
v_mfma_f32_16x16x32_bf16 v[248:251], a[20:23], a[108:111], v[248:251]
ds_read_b64_tr_b16 a[122:123], v23 offset:24832
v_mfma_f32_16x16x32_bf16 v[248:251], a[16:19], a[104:107], v[248:251]
ds_read_b64_tr_b16 a[124:125], v23 offset:36864
v_mfma_f32_16x16x32_bf16 v[236:239], a[8:11], a[104:107], v[236:239]
buffer_load_dwordx4 v18, s[40:43], s31 offen offset:1024  lds
v_mfma_f32_16x16x32_bf16 v[236:239], a[12:15], a[108:111], v[236:239]
ds_read_b64_tr_b16 a[126:127], v23 offset:37120
v_mfma_f32_16x16x32_bf16 v[232:235], a[4:7], a[108:111], v[232:235]
v_mfma_f32_16x16x32_bf16 v[232:235], a[0:3], a[104:107], v[232:235]
v_mfma_f32_16x16x32_bf16 v[160:163], a[64:67], a[0:3], v[160:163]
v_mfma_f32_16x16x32_bf16 v[160:163], a[68:71], a[4:7], v[160:163]
v_mfma_f32_16x16x32_bf16 v[168:171], a[68:71], a[12:15], v[168:171]
buffer_load_dwordx4 v19, s[40:43], s31 offen offset:2048  lds
v_mfma_f32_16x16x32_bf16 v[168:171], a[64:67], a[8:11], v[168:171]
v_mfma_f32_16x16x32_bf16 v[176:179], a[64:67], a[16:19], v[176:179]
v_mfma_f32_16x16x32_bf16 v[176:179], a[68:71], a[20:23], v[176:179]
v_mfma_f32_16x16x32_bf16 v[184:187], a[68:71], a[28:31], v[184:187]
v_mfma_f32_16x16x32_bf16 v[184:187], a[64:67], a[24:27], v[184:187]
s_add_u32 m0, s27, 0
s_waitcnt vmcnt(13) lgkmcnt(0)
s_barrier
v_mfma_f32_16x16x32_bf16 v[188:191], a[72:75], a[24:27], v[188:191]
buffer_load_dwordx4 v10, s[8:11], s30 offen offset:0  lds
v_mfma_f32_16x16x32_bf16 v[188:191], a[76:79], a[28:31], v[188:191]
ds_read_b32 v50, v48 offset:16384
v_mfma_f32_16x16x32_bf16 v[180:183], a[76:79], a[20:23], v[180:183]
ds_read_b32 v51, v49 offset:128
v_mfma_f32_16x16x32_bf16 v[180:183], a[72:75], a[16:19], v[180:183]
ds_read_b128 a[32:35], v20 offset:16384
v_mfma_f32_16x16x32_bf16 v[172:175], a[72:75], a[8:11], v[172:175]
ds_read_b128 a[36:39], v21 offset:16384
v_mfma_f32_16x16x32_bf16 v[172:175], a[76:79], a[12:15], v[172:175]
ds_read_b128 a[40:43], v20 offset:18432
v_mfma_f32_16x16x32_bf16 v[164:167], a[76:79], a[4:7], v[164:167]
buffer_load_dwordx4 v11, s[8:11], s30 offen offset:1024  lds
v_mfma_f32_16x16x32_bf16 v[164:167], a[72:75], a[0:3], v[164:167]
ds_read_b128 a[44:47], v21 offset:18432
v_mfma_f32_16x16x32_bf16 v[96:99], a[0:3], a[128:131], v[96:99]
ds_read_b128 a[48:51], v20 offset:20480
v_mfma_f32_16x16x32_bf16 v[96:99], a[4:7], a[132:135], v[96:99]
ds_read_b128 a[52:55], v21 offset:20480
v_mfma_f32_16x16x32_bf16 v[100:103], a[12:15], a[132:135], v[100:103]
ds_read_b128 a[56:59], v20 offset:22528
v_mfma_f32_16x16x32_bf16 v[100:103], a[8:11], a[128:131], v[100:103]
ds_read_b128 a[60:63], v21 offset:22528
v_mfma_f32_16x16x32_bf16 v[112:115], a[16:19], a[128:131], v[112:115]
buffer_load_dwordx4 v12, s[8:11], s30 offen offset:2048  lds
v_mfma_f32_16x16x32_bf16 v[112:115], a[20:23], a[132:135], v[112:115]
ds_read_b64_tr_b16 a[80:81], v24 offset:1024
v_mfma_f32_16x16x32_bf16 v[116:119], a[28:31], a[132:135], v[116:119]
ds_read_b64_tr_b16 a[82:83], v24 offset:1280
v_mfma_f32_16x16x32_bf16 v[116:119], a[24:27], a[128:131], v[116:119]
ds_read_b64_tr_b16 a[84:85], v24 offset:13312
v_mfma_f32_16x16x32_bf16 v[124:127], a[24:27], a[136:139], v[124:127]
ds_read_b64_tr_b16 a[86:87], v24 offset:13568
v_mfma_f32_16x16x32_bf16 v[124:127], a[28:31], a[140:143], v[124:127]
ds_read_b64_tr_b16 a[88:89], v25 offset:1024
v_mfma_f32_16x16x32_bf16 v[120:123], a[20:23], a[140:143], v[120:123]
buffer_load_dwordx4 v13, s[8:11], s30 offen offset:3072  lds
s_add_u32 s30, s30, 128
v_mfma_f32_16x16x32_bf16 v[120:123], a[16:19], a[136:139], v[120:123]
ds_read_b64_tr_b16 a[90:91], v25 offset:1280
v_mfma_f32_16x16x32_bf16 v[108:111], a[8:11], a[136:139], v[108:111]
ds_read_b64_tr_b16 a[92:93], v25 offset:13312
v_mfma_f32_16x16x32_bf16 v[108:111], a[12:15], a[140:143], v[108:111]
ds_read_b64_tr_b16 a[94:95], v25 offset:13568
v_mfma_f32_16x16x32_bf16 v[104:107], a[4:7], a[140:143], v[104:107]
ds_read_b64_tr_b16 a[96:97], v24 offset:2048
v_mfma_f32_16x16x32_bf16 v[104:107], a[0:3], a[136:139], v[104:107]
s_add_u32 m0, s28, 24576
ds_read_b64_tr_b16 a[98:99], v24 offset:2304
v_mfma_f32_16x16x32_bf16 v[128:131], a[0:3], a[144:147], v[128:131]
buffer_load_dwordx4 v14, s[12:15], s31 offen offset:0  lds
v_mfma_f32_16x16x32_bf16 v[128:131], a[4:7], a[148:151], v[128:131]
ds_read_b64_tr_b16 a[100:101], v24 offset:14336
v_mfma_f32_16x16x32_bf16 v[132:135], a[12:15], a[148:151], v[132:135]
ds_read_b64_tr_b16 a[102:103], v24 offset:14592
v_mfma_f32_16x16x32_bf16 v[132:135], a[8:11], a[144:147], v[132:135]
ds_read_b64_tr_b16 a[104:105], v25 offset:2048
v_mfma_f32_16x16x32_bf16 v[144:147], a[16:19], a[144:147], v[144:147]
ds_read_b64_tr_b16 a[106:107], v25 offset:2304
v_mfma_f32_16x16x32_bf16 v[144:147], a[20:23], a[148:151], v[144:147]
ds_read_b64_tr_b16 a[108:109], v25 offset:14336
v_mfma_f32_16x16x32_bf16 v[148:151], a[28:31], a[148:151], v[148:151]
buffer_load_dwordx4 v15, s[12:15], s31 offen offset:1024  lds
v_mfma_f32_16x16x32_bf16 v[148:151], a[24:27], a[144:147], v[148:151]
ds_read_b64_tr_b16 a[110:111], v25 offset:14592
v_mfma_f32_16x16x32_bf16 v[156:159], a[24:27], a[152:155], v[156:159]
ds_read_b64_tr_b16 a[64:65], v24 offset:0
v_mfma_f32_16x16x32_bf16 v[156:159], a[28:31], a[156:159], v[156:159]
ds_read_b64_tr_b16 a[66:67], v24 offset:256
v_mfma_f32_16x16x32_bf16 v[152:155], a[20:23], a[156:159], v[152:155]
ds_read_b64_tr_b16 a[68:69], v24 offset:12288
v_mfma_f32_16x16x32_bf16 v[152:155], a[16:19], a[152:155], v[152:155]
ds_read_b64_tr_b16 a[70:71], v24 offset:12544
v_mfma_f32_16x16x32_bf16 v[140:143], a[8:11], a[152:155], v[140:143]
buffer_load_dwordx4 v16, s[12:15], s31 offen offset:2048  lds
v_mfma_f32_16x16x32_bf16 v[140:143], a[12:15], a[156:159], v[140:143]
ds_read_b64_tr_b16 a[72:73], v25 offset:0
v_mfma_f32_16x16x32_bf16 v[136:139], a[4:7], a[156:159], v[136:139]
ds_read_b64_tr_b16 a[74:75], v25 offset:256
v_mfma_f32_16x16x32_bf16 v[136:139], a[0:3], a[152:155], v[136:139]
ds_read_b64_tr_b16 a[76:77], v25 offset:12288
v_mfma_f32_16x16x32_bf16 v[64:67], a[112:115], a[0:3], v[64:67]
ds_read_b64_tr_b16 a[78:79], v25 offset:12544
v_mfma_f32_16x16x32_bf16 v[64:67], a[116:119], a[4:7], v[64:67]
s_add_u32 m0, s28, 27648
v_mfma_f32_16x16x32_bf16 v[72:75], a[116:119], a[12:15], v[72:75]
buffer_load_dwordx4 v17, s[12:15], s31 offen offset:0  lds
v_mfma_f32_16x16x32_bf16 v[72:75], a[112:115], a[8:11], v[72:75]
v_mfma_f32_16x16x32_bf16 v[80:83], a[112:115], a[16:19], v[80:83]
v_mfma_f32_16x16x32_bf16 v[80:83], a[116:119], a[20:23], v[80:83]
v_mfma_f32_16x16x32_bf16 v[88:91], a[116:119], a[28:31], v[88:91]
v_mfma_f32_16x16x32_bf16 v[88:91], a[112:115], a[24:27], v[88:91]
s_waitcnt vmcnt(15) lgkmcnt(0)
s_barrier
v_mfma_f32_16x16x32_bf16 v[92:95], a[120:123], a[24:27], v[92:95]
buffer_load_dwordx4 v18, s[12:15], s31 offen offset:1024  lds
v_mfma_f32_16x16x32_bf16 v[92:95], a[124:127], a[28:31], v[92:95]
v_lshlrev_b32 v52, 16, v50
v_lshlrev_b32 v47, 16, v51
v_mfma_f32_16x16x32_bf16 v[84:87], a[124:127], a[20:23], v[84:87]
v_and_b32 v50, 0xffff0000, v50
v_fmac_f32 v1, v52, v47
v_mfma_f32_16x16x32_bf16 v[84:87], a[120:123], a[16:19], v[84:87]
v_and_b32 v47, 0xffff0000, v51
v_fmac_f32 v1, v50, v47
v_mfma_f32_16x16x32_bf16 v[76:79], a[120:123], a[8:11], v[76:79]
v_add_u32 v49, 128, v49
v_mfma_f32_16x16x32_bf16 v[76:79], a[124:127], a[12:15], v[76:79]
v_mfma_f32_16x16x32_bf16 v[68:71], a[124:127], a[4:7], v[68:71]
buffer_load_dwordx4 v19, s[12:15], s31 offen offset:2048  lds
s_add_u32 s31, s31, 393216
v_mfma_f32_16x16x32_bf16 v[68:71], a[120:123], a[0:3], v[68:71]
v_mfma_f32_16x16x32_bf16 v[192:195], a[80:83], a[32:35], v[192:195]
buffer_load_dword v0, v26, s[4:7], s3 offen
s_add_u32 s3, s3, s37
v_mfma_f32_16x16x32_bf16 v[192:195], a[84:87], a[36:39], v[192:195]
s_cmp_eq_u32 s39, s38
s_cselect_b32 s25, s65, 0x1000
s_mov_b64 exec, 1
buffer_atomic_add v28, v9, s[52:55], s25 offen sc1
s_mov_b64 exec, -1
v_mfma_f32_16x16x32_bf16 v[200:203], a[84:87], a[44:47], v[200:203]
ds_read_b64_tr_b16 a[128:129], v24 offset:25600
v_mfma_f32_16x16x32_bf16 v[200:203], a[80:83], a[40:43], v[200:203]
s_add_u32 m0, s28, 49152
ds_read_b64_tr_b16 a[130:131], v24 offset:25856
v_mfma_f32_16x16x32_bf16 v[208:211], a[80:83], a[48:51], v[208:211]
buffer_load_dwordx4 v14, s[40:43], s31 offen offset:0  lds
v_mfma_f32_16x16x32_bf16 v[208:211], a[84:87], a[52:55], v[208:211]
ds_read_b64_tr_b16 a[132:133], v24 offset:37888
v_mfma_f32_16x16x32_bf16 v[216:219], a[84:87], a[60:63], v[216:219]
ds_read_b64_tr_b16 a[134:135], v24 offset:38144
v_mfma_f32_16x16x32_bf16 v[216:219], a[80:83], a[56:59], v[216:219]
ds_read_b64_tr_b16 a[136:137], v25 offset:25600
v_mfma_f32_16x16x32_bf16 v[220:223], a[88:91], a[56:59], v[220:223]
ds_read_b64_tr_b16 a[138:139], v25 offset:25856
v_mfma_f32_16x16x32_bf16 v[220:223], a[92:95], a[60:63], v[220:223]
ds_read_b64_tr_b16 a[140:141], v25 offset:37888
v_mfma_f32_16x16x32_bf16 v[212:215], a[92:95], a[52:55], v[212:215]
buffer_load_dwordx4 v15, s[40:43], s31 offen offset:1024  lds
v_mfma_f32_16x16x32_bf16 v[212:215], a[88:91], a[48:51], v[212:215]
ds_read_b64_tr_b16 a[142:143], v25 offset:38144
v_mfma_f32_16x16x32_bf16 v[204:207], a[88:91], a[40:43], v[204:207]
ds_read_b64_tr_b16 a[144:145], v24 offset:26624
v_mfma_f32_16x16x32_bf16 v[204:207], a[92:95], a[44:47], v[204:207]
ds_read_b64_tr_b16 a[146:147], v24 offset:26880
v_mfma_f32_16x16x32_bf16 v[196:199], a[92:95], a[36:39], v[196:199]
ds_read_b64_tr_b16 a[148:149], v24 offset:38912
v_mfma_f32_16x16x32_bf16 v[196:199], a[88:91], a[32:35], v[196:199]
ds_read_b64_tr_b16 a[150:151], v24 offset:39168
v_mfma_f32_16x16x32_bf16 v[224:227], a[32:35], a[96:99], v[224:227]
buffer_load_dwordx4 v16, s[40:43], s31 offen offset:2048  lds
v_mfma_f32_16x16x32_bf16 v[224:227], a[36:39], a[100:103], v[224:227]
ds_read_b64_tr_b16 a[152:153], v25 offset:26624
v_mfma_f32_16x16x32_bf16 v[228:231], a[44:47], a[100:103], v[228:231]
ds_read_b64_tr_b16 a[154:155], v25 offset:26880
v_mfma_f32_16x16x32_bf16 v[228:231], a[40:43], a[96:99], v[228:231]
ds_read_b64_tr_b16 a[156:157], v25 offset:38912
v_mfma_f32_16x16x32_bf16 v[240:243], a[48:51], a[96:99], v[240:243]
ds_read_b64_tr_b16 a[158:159], v25 offset:39168
v_mfma_f32_16x16x32_bf16 v[240:243], a[52:55], a[100:103], v[240:243]
s_add_u32 m0, s28, 52224
ds_read_b64_tr_b16 a[112:113], v24 offset:24576
v_mfma_f32_16x16x32_bf16 v[244:247], a[60:63], a[100:103], v[244:247]
buffer_load_dwordx4 v17, s[40:43], s31 offen offset:0  lds
v_mfma_f32_16x16x32_bf16 v[244:247], a[56:59], a[96:99], v[244:247]
ds_read_b64_tr_b16 a[114:115], v24 offset:24832
v_mfma_f32_16x16x32_bf16 v[252:255], a[56:59], a[104:107], v[252:255]
ds_read_b64_tr_b16 a[116:117], v24 offset:36864
v_mfma_f32_16x16x32_bf16 v[252:255], a[60:63], a[108:111], v[252:255]
ds_read_b64_tr_b16 a[118:119], v24 offset:37120
v_mfma_f32_16x16x32_bf16 v[248:251], a[52:55], a[108:111], v[248:251]
ds_read_b64_tr_b16 a[120:121], v25 offset:24576
v_mfma_f32_16x16x32_bf16 v[248:251], a[48:51], a[104:107], v[248:251]
ds_read_b64_tr_b16 a[122:123], v25 offset:24832
v_mfma_f32_16x16x32_bf16 v[236:239], a[40:43], a[104:107], v[236:239]
buffer_load_dwordx4 v18, s[40:43], s31 offen offset:1024  lds
v_mfma_f32_16x16x32_bf16 v[236:239], a[44:47], a[108:111], v[236:239]
ds_read_b64_tr_b16 a[124:125], v25 offset:36864
v_mfma_f32_16x16x32_bf16 v[232:235], a[36:39], a[108:111], v[232:235]
ds_read_b64_tr_b16 a[126:127], v25 offset:37120
v_mfma_f32_16x16x32_bf16 v[232:235], a[32:35], a[104:107], v[232:235]
v_mfma_f32_16x16x32_bf16 v[160:163], a[64:67], a[32:35], v[160:163]
v_mfma_f32_16x16x32_bf16 v[160:163], a[68:71], a[36:39], v[160:163]
v_mfma_f32_16x16x32_bf16 v[168:171], a[68:71], a[44:47], v[168:171]
buffer_load_dwordx4 v19, s[40:43], s31 offen offset:2048  lds
v_mfma_f32_16x16x32_bf16 v[168:171], a[64:67], a[40:43], v[168:171]
v_mfma_f32_16x16x32_bf16 v[176:179], a[64:67], a[48:51], v[176:179]
v_mfma_f32_16x16x32_bf16 v[176:179], a[68:71], a[52:55], v[176:179]
v_mfma_f32_16x16x32_bf16 v[184:187], a[68:71], a[60:63], v[184:187]
v_mfma_f32_16x16x32_bf16 v[184:187], a[64:67], a[56:59], v[184:187]
s_add_u32 m0, s27, 16384
s_waitcnt vmcnt(14) lgkmcnt(0)
s_barrier
v_mfma_f32_16x16x32_bf16 v[188:191], a[72:75], a[56:59], v[188:191]
buffer_load_dwordx4 v10, s[8:11], s30 offen offset:0  lds
v_mfma_f32_16x16x32_bf16 v[188:191], a[76:79], a[60:63], v[188:191]
ds_read_b32 v50, v48 offset:0
v_mfma_f32_16x16x32_bf16 v[180:183], a[76:79], a[52:55], v[180:183]
ds_read_b32 v51, v49 offset:128
v_mfma_f32_16x16x32_bf16 v[180:183], a[72:75], a[48:51], v[180:183]
ds_read_b128 a[0:3], v20 offset:0
v_mfma_f32_16x16x32_bf16 v[172:175], a[72:75], a[40:43], v[172:175]
ds_read_b128 a[4:7], v21 offset:0
v_mfma_f32_16x16x32_bf16 v[172:175], a[76:79], a[44:47], v[172:175]
ds_read_b128 a[8:11], v20 offset:2048
v_mfma_f32_16x16x32_bf16 v[164:167], a[76:79], a[36:39], v[164:167]
buffer_load_dwordx4 v11, s[8:11], s30 offen offset:1024  lds
v_mfma_f32_16x16x32_bf16 v[164:167], a[72:75], a[32:35], v[164:167]
ds_read_b128 a[12:15], v21 offset:2048
v_mfma_f32_16x16x32_bf16 v[96:99], a[32:35], a[128:131], v[96:99]
ds_read_b128 a[16:19], v20 offset:4096
v_mfma_f32_16x16x32_bf16 v[96:99], a[36:39], a[132:135], v[96:99]
ds_read_b128 a[20:23], v21 offset:4096
v_mfma_f32_16x16x32_bf16 v[100:103], a[44:47], a[132:135], v[100:103]
ds_read_b128 a[24:27], v20 offset:6144
v_mfma_f32_16x16x32_bf16 v[100:103], a[40:43], a[128:131], v[100:103]
ds_read_b128 a[28:31], v21 offset:6144
v_mfma_f32_16x16x32_bf16 v[112:115], a[48:51], a[128:131], v[112:115]
buffer_load_dwordx4 v12, s[8:11], s30 offen offset:2048  lds
v_mfma_f32_16x16x32_bf16 v[112:115], a[52:55], a[132:135], v[112:115]
ds_read_b64_tr_b16 a[80:81], v22 offset:1024
v_mfma_f32_16x16x32_bf16 v[116:119], a[60:63], a[132:135], v[116:119]
ds_read_b64_tr_b16 a[82:83], v22 offset:1280
v_mfma_f32_16x16x32_bf16 v[116:119], a[56:59], a[128:131], v[116:119]
ds_read_b64_tr_b16 a[84:85], v22 offset:13312
v_mfma_f32_16x16x32_bf16 v[124:127], a[56:59], a[136:139], v[124:127]
ds_read_b64_tr_b16 a[86:87], v22 offset:13568
v_mfma_f32_16x16x32_bf16 v[124:127], a[60:63], a[140:143], v[124:127]
ds_read_b64_tr_b16 a[88:89], v23 offset:1024
v_mfma_f32_16x16x32_bf16 v[120:123], a[52:55], a[140:143], v[120:123]
buffer_load_dwordx4 v13, s[8:11], s30 offen offset:3072  lds
s_add_u32 s30, s30, 128
v_mfma_f32_16x16x32_bf16 v[120:123], a[48:51], a[136:139], v[120:123]
ds_read_b64_tr_b16 a[90:91], v23 offset:1280
v_mfma_f32_16x16x32_bf16 v[108:111], a[40:43], a[136:139], v[108:111]
ds_read_b64_tr_b16 a[92:93], v23 offset:13312
v_mfma_f32_16x16x32_bf16 v[108:111], a[44:47], a[140:143], v[108:111]
ds_read_b64_tr_b16 a[94:95], v23 offset:13568
v_mfma_f32_16x16x32_bf16 v[104:107], a[36:39], a[140:143], v[104:107]
ds_read_b64_tr_b16 a[96:97], v22 offset:2048
v_mfma_f32_16x16x32_bf16 v[104:107], a[32:35], a[136:139], v[104:107]
s_add_u32 m0, s28, 73728
ds_read_b64_tr_b16 a[98:99], v22 offset:2304
v_mfma_f32_16x16x32_bf16 v[128:131], a[32:35], a[144:147], v[128:131]
buffer_load_dwordx4 v14, s[12:15], s31 offen offset:0  lds
v_mfma_f32_16x16x32_bf16 v[128:131], a[36:39], a[148:151], v[128:131]
ds_read_b64_tr_b16 a[100:101], v22 offset:14336
v_mfma_f32_16x16x32_bf16 v[132:135], a[44:47], a[148:151], v[132:135]
ds_read_b64_tr_b16 a[102:103], v22 offset:14592
v_mfma_f32_16x16x32_bf16 v[132:135], a[40:43], a[144:147], v[132:135]
ds_read_b64_tr_b16 a[104:105], v23 offset:2048
v_mfma_f32_16x16x32_bf16 v[144:147], a[48:51], a[144:147], v[144:147]
ds_read_b64_tr_b16 a[106:107], v23 offset:2304
v_mfma_f32_16x16x32_bf16 v[144:147], a[52:55], a[148:151], v[144:147]
ds_read_b64_tr_b16 a[108:109], v23 offset:14336
v_mfma_f32_16x16x32_bf16 v[148:151], a[60:63], a[148:151], v[148:151]
buffer_load_dwordx4 v15, s[12:15], s31 offen offset:1024  lds
v_mfma_f32_16x16x32_bf16 v[148:151], a[56:59], a[144:147], v[148:151]
ds_read_b64_tr_b16 a[110:111], v23 offset:14592
v_mfma_f32_16x16x32_bf16 v[156:159], a[56:59], a[152:155], v[156:159]
ds_read_b64_tr_b16 a[64:65], v22 offset:0
v_mfma_f32_16x16x32_bf16 v[156:159], a[60:63], a[156:159], v[156:159]
ds_read_b64_tr_b16 a[66:67], v22 offset:256
v_mfma_f32_16x16x32_bf16 v[152:155], a[52:55], a[156:159], v[152:155]
ds_read_b64_tr_b16 a[68:69], v22 offset:12288
v_mfma_f32_16x16x32_bf16 v[152:155], a[48:51], a[152:155], v[152:155]
ds_read_b64_tr_b16 a[70:71], v22 offset:12544
v_mfma_f32_16x16x32_bf16 v[140:143], a[40:43], a[152:155], v[140:143]
buffer_load_dwordx4 v16, s[12:15], s31 offen offset:2048  lds
v_mfma_f32_16x16x32_bf16 v[140:143], a[44:47], a[156:159], v[140:143]
ds_read_b64_tr_b16 a[72:73], v23 offset:0
v_mfma_f32_16x16x32_bf16 v[136:139], a[36:39], a[156:159], v[136:139]
ds_read_b64_tr_b16 a[74:75], v23 offset:256
v_mfma_f32_16x16x32_bf16 v[136:139], a[32:35], a[152:155], v[136:139]
ds_read_b64_tr_b16 a[76:77], v23 offset:12288
v_mfma_f32_16x16x32_bf16 v[64:67], a[112:115], a[32:35], v[64:67]
ds_read_b64_tr_b16 a[78:79], v23 offset:12544
v_mfma_f32_16x16x32_bf16 v[64:67], a[116:119], a[36:39], v[64:67]
s_add_u32 m0, s28, 76800
v_mfma_f32_16x16x32_bf16 v[72:75], a[116:119], a[44:47], v[72:75]
buffer_load_dwordx4 v17, s[12:15], s31 offen offset:0  lds
v_mfma_f32_16x16x32_bf16 v[72:75], a[112:115], a[40:43], v[72:75]
v_mfma_f32_16x16x32_bf16 v[80:83], a[112:115], a[48:51], v[80:83]
v_mfma_f32_16x16x32_bf16 v[80:83], a[116:119], a[52:55], v[80:83]
v_mfma_f32_16x16x32_bf16 v[88:91], a[116:119], a[60:63], v[88:91]
v_mfma_f32_16x16x32_bf16 v[88:91], a[112:115], a[56:59], v[88:91]
s_waitcnt vmcnt(16) lgkmcnt(0)
s_barrier
v_mfma_f32_16x16x32_bf16 v[92:95], a[120:123], a[56:59], v[92:95]
buffer_load_dwordx4 v18, s[12:15], s31 offen offset:1024  lds
v_mfma_f32_16x16x32_bf16 v[92:95], a[124:127], a[60:63], v[92:95]
v_lshlrev_b32 v52, 16, v50
v_lshlrev_b32 v47, 16, v51
v_mfma_f32_16x16x32_bf16 v[84:87], a[124:127], a[52:55], v[84:87]
v_and_b32 v50, 0xffff0000, v50
v_fmac_f32 v1, v52, v47
v_mfma_f32_16x16x32_bf16 v[84:87], a[120:123], a[48:51], v[84:87]
v_and_b32 v47, 0xffff0000, v51
v_fmac_f32 v1, v50, v47
v_mfma_f32_16x16x32_bf16 v[76:79], a[120:123], a[40:43], v[76:79]
v_add_u32 v49, 128, v49
v_mfma_f32_16x16x32_bf16 v[76:79], a[124:127], a[44:47], v[76:79]
v_mfma_f32_16x16x32_bf16 v[68:71], a[124:127], a[36:39], v[68:71]
buffer_load_dwordx4 v19, s[12:15], s31 offen offset:2048  lds
s_add_u32 s31, s31, 393216
s_cmp_lg_u32 s39, 0
v_mfma_f32_16x16x32_bf16 v[68:71], a[120:123], a[32:35], v[68:71]
s_cbranch_scc1 L_loop0_0
L_out0:
v_mfma_f32_16x16x32_bf16 v[192:195], a[80:83], a[0:3], v[192:195]
ds_read_b64_tr_b16 a[128:129], v22 offset:25600
v_mfma_f32_16x16x32_bf16 v[192:195], a[84:87], a[4:7], v[192:195]
ds_read_b64_tr_b16 a[130:131], v22 offset:25856
v_mfma_f32_16x16x32_bf16 v[200:203], a[84:87], a[12:15], v[200:203]
ds_read_b64_tr_b16 a[132:133], v22 offset:37888
v_mfma_f32_16x16x32_bf16 v[200:203], a[80:83], a[8:11], v[200:203]
s_add_u32 m0, s28, 0
ds_read_b64_tr_b16 a[134:135], v22 offset:38144
v_mfma_f32_16x16x32_bf16 v[208:211], a[80:83], a[16:19], v[208:211]
buffer_load_dwordx4 v14, s[40:43], s31 offen offset:0  lds
v_mfma_f32_16x16x32_bf16 v[208:211], a[84:87], a[20:23], v[208:211]
ds_read_b64_tr_b16 a[136:137], v23 offset:25600
v_mfma_f32_16x16x32_bf16 v[216:219], a[84:87], a[28:31], v[216:219]
ds_read_b64_tr_b16 a[138:139], v23 offset:25856
v_mfma_f32_16x16x32_bf16 v[216:219], a[80:83], a[24:27], v[216:219]
ds_read_b64_tr_b16 a[140:141], v23 offset:37888
v_mfma_f32_16x16x32_bf16 v[220:223], a[88:91], a[24:27], v[220:223]
ds_read_b64_tr_b16 a[142:143], v23 offset:38144
v_mfma_f32_16x16x32_bf16 v[220:223], a[92:95], a[28:31], v[220:223]
ds_read_b64_tr_b16 a[144:145], v22 offset:26624
v_mfma_f32_16x16x32_bf16 v[212:215], a[92:95], a[20:23], v[212:215]
buffer_load_dwordx4 v15, s[40:43], s31 offen offset:1024  lds
v_mfma_f32_16x16x32_bf16 v[212:215], a[88:91], a[16:19], v[212:215]
ds_read_b64_tr_b16 a[146:147], v22 offset:26880
v_mfma_f32_16x16x32_bf16 v[204:207], a[88:91], a[8:11], v[204:207]
ds_read_b64_tr_b16 a[148:149], v22 offset:38912
v_mfma_f32_16x16x32_bf16 v[204:207], a[92:95], a[12:15], v[204:207]
ds_read_b64_tr_b16 a[150:151], v22 offset:39168
v_mfma_f32_16x16x32_bf16 v[196:199], a[92:95], a[4:7], v[196:199]
ds_read_b64_tr_b16 a[152:153], v23 offset:26624
v_mfma_f32_16x16x32_bf16 v[196:199], a[88:91], a[0:3], v[196:199]
ds_read_b64_tr_b16 a[154:155], v23 offset:26880
v_mfma_f32_16x16x32_bf16 v[224:227], a[0:3], a[96:99], v[224:227]
buffer_load_dwordx4 v16, s[40:43], s31 offen offset:2048  lds
v_mfma_f32_16x16x32_bf16 v[224:227], a[4:7], a[100:103], v[224:227]
ds_read_b64_tr_b16 a[156:157], v23 offset:38912
v_mfma_f32_16x16x32_bf16 v[228:231], a[12:15], a[100:103], v[228:231]
ds_read_b64_tr_b16 a[158:159], v23 offset:39168
v_mfma_f32_16x16x32_bf16 v[228:231], a[8:11], a[96:99], v[228:231]
ds_read_b64_tr_b16 a[112:113], v22 offset:24576
v_mfma_f32_16x16x32_bf16 v[240:243], a[16:19], a[96:99], v[240:243]
ds_read_b64_tr_b16 a[114:115], v22 offset:24832
v_mfma_f32_16x16x32_bf16 v[240:243], a[20:23], a[100:103], v[240:243]
s_add_u32 m0, s28, 3072
ds_read_b64_tr_b16 a[116:117], v22 offset:36864
v_mfma_f32_16x16x32_bf16 v[244:247], a[28:31], a[100:103], v[244:247]
buffer_load_dwordx4 v17, s[40:43], s31 offen offset:0  lds
v_mfma_f32_16x16x32_bf16 v[244:247], a[24:27], a[96:99], v[244:247]
ds_read_b64_tr_b16 a[118:119], v22 offset:37120
v_mfma_f32_16x16x32_bf16 v[252:255], a[24:27], a[104:107], v[252:255]
ds_read_b64_tr_b16 a[120:121], v23 offset:24576
v_mfma_f32_16x16x32_bf16 v[252:255], a[28:31], a[108:111], v[252:255]
ds_read_b64_tr_b16 a[122:123], v23 offset:24832
v_mfma_f32_16x16x32_bf16 v[248:251], a[20:23], a[108:111], v[248:251]
ds_read_b64_tr_b16 a[124:125], v23 offset:36864
v_mfma_f32_16x16x32_bf16 v[248:251], a[16:19], a[104:107], v[248:251]
ds_read_b64_tr_b16 a[126:127], v23 offset:37120
v_mfma_f32_16x16x32_bf16 v[236:239], a[8:11], a[104:107], v[236:239]
buffer_load_dwordx4 v18, s[40:43], s31 offen offset:1024  lds
v_mfma_f32_16x16x32_bf16 v[236:239], a[12:15], a[108:111], v[236:239]
v_mfma_f32_16x16x32_bf16 v[232:235], a[4:7], a[108:111], v[232:235]
v_mfma_f32_16x16x32_bf16 v[232:235], a[0:3], a[104:107], v[232:235]
v_mfma_f32_16x16x32_bf16 v[160:163], a[64:67], a[0:3], v[160:163]
v_mfma_f32_16x16x32_bf16 v[160:163], a[68:71], a[4:7], v[160:163]
v_mfma_f32_16x16x32_bf16 v[168:171], a[68:71], a[12:15], v[168:171]
buffer_load_dwordx4 v19, s[40:43], s31 offen offset:2048  lds
v_mfma_f32_16x16x32_bf16 v[168:171], a[64:67], a[8:11], v[168:171]
v_mfma_f32_16x16x32_bf16 v[176:179], a[64:67], a[16:19], v[176:179]
v_mfma_f32_16x16x32_bf16 v[176:179], a[68:71], a[20:23], v[176:179]
v_mfma_f32_16x16x32_bf16 v[184:187], a[68:71], a[28:31], v[184:187]
v_mfma_f32_16x16x32_bf16 v[184:187], a[64:67], a[24:27], v[184:187]
s_add_u32 m0, s27, 0
s_waitcnt vmcnt(12) lgkmcnt(0)
s_barrier
v_mfma_f32_16x16x32_bf16 v[188:191], a[72:75], a[24:27], v[188:191]
buffer_load_dwordx4 v10, s[8:11], s30 offen offset:0  lds
v_mfma_f32_16x16x32_bf16 v[188:191], a[76:79], a[28:31], v[188:191]
ds_read_b32 v50, v48 offset:16384
v_mfma_f32_16x16x32_bf16 v[180:183], a[76:79], a[20:23], v[180:183]
ds_read_b32 v51, v49 offset:128
v_mfma_f32_16x16x32_bf16 v[180:183], a[72:75], a[16:19], v[180:183]
ds_read_b32 v44, v49 offset:256
v_mfma_f32_16x16x32_bf16 v[172:175], a[72:75], a[8:11], v[172:175]
ds_read_b32 v43, v49 offset:384
v_mfma_f32_16x16x32_bf16 v[172:175], a[76:79], a[12:15], v[172:175]
ds_read_b128 a[32:35], v20 offset:16384
v_mfma_f32_16x16x32_bf16 v[164:167], a[76:79], a[4:7], v[164:167]
buffer_load_dwordx4 v11, s[8:11], s30 offen offset:1024  lds
v_mfma_f32_16x16x32_bf16 v[164:167], a[72:75], a[0:3], v[164:167]
ds_read_b128 a[36:39], v21 offset:16384
v_mfma_f32_16x16x32_bf16 v[96:99], a[0:3], a[128:131], v[96:99]
ds_read_b128 a[40:43], v20 offset:18432
v_mfma_f32_16x16x32_bf16 v[96:99], a[4:7], a[132:135], v[96:99]
ds_read_b128 a[44:47], v21 offset:18432
v_mfma_f32_16x16x32_bf16 v[100:103], a[12:15], a[132:135], v[100:103]
ds_read_b128 a[48:51], v20 offset:20480
v_mfma_f32_16x16x32_bf16 v[100:103], a[8:11], a[128:131], v[100:103]
ds_read_b128 a[52:55], v21 offset:20480
v_mfma_f32_16x16x32_bf16 v[112:115], a[16:19], a[128:131], v[112:115]
buffer_load_dwordx4 v12, s[8:11], s30 offen offset:2048  lds
v_mfma_f32_16x16x32_bf16 v[112:115], a[20:23], a[132:135], v[112:115]
ds_read_b128 a[56:59], v20 offset:22528
v_mfma_f32_16x16x32_bf16 v[116:119], a[28:31], a[132:135], v[116:119]
ds_read_b128 a[60:63], v21 offset:22528
v_mfma_f32_16x16x32_bf16 v[116:119], a[24:27], a[128:131], v[116:119]
ds_read_b64_tr_b16 a[80:81], v24 offset:1024
v_mfma_f32_16x16x32_bf16 v[124:127], a[24:27], a[136:139], v[124:127]
ds_read_b64_tr_b16 a[82:83], v24 offset:1280
v_mfma_f32_16x16x32_bf16 v[124:127], a[28:31], a[140:143], v[124:127]
ds_read_b64_tr_b16 a[84:85], v24 offset:13312
v_mfma_f32_16x16x32_bf16 v[120:123], a[20:23], a[140:143], v[120:123]
buffer_load_dwordx4 v13, s[8:11], s30 offen offset:3072  lds
s_add_u32 s30, s30, 128
v_mfma_f32_16x16x32_bf16 v[120:123], a[16:19], a[136:139], v[120:123]
ds_read_b64_tr_b16 a[86:87], v24 offset:13568
v_mfma_f32_16x16x32_bf16 v[108:111], a[8:11], a[136:139], v[108:111]
ds_read_b64_tr_b16 a[88:89], v25 offset:1024
v_mfma_f32_16x16x32_bf16 v[108:111], a[12:15], a[140:143], v[108:111]
ds_read_b64_tr_b16 a[90:91], v25 offset:1280
v_mfma_f32_16x16x32_bf16 v[104:107], a[4:7], a[140:143], v[104:107]
ds_read_b64_tr_b16 a[92:93], v25 offset:13312
v_mfma_f32_16x16x32_bf16 v[104:107], a[0:3], a[136:139], v[104:107]
s_add_u32 m0, s28, 24576
ds_read_b64_tr_b16 a[94:95], v25 offset:13568
v_mfma_f32_16x16x32_bf16 v[128:131], a[0:3], a[144:147], v[128:131]
buffer_load_dwordx4 v14, s[12:15], s31 offen offset:0  lds
v_mfma_f32_16x16x32_bf16 v[128:131], a[4:7], a[148:151], v[128:131]
ds_read_b64_tr_b16 a[96:97], v24 offset:2048
v_mfma_f32_16x16x32_bf16 v[132:135], a[12:15], a[148:151], v[132:135]
ds_read_b64_tr_b16 a[98:99], v24 offset:2304
v_mfma_f32_16x16x32_bf16 v[132:135], a[8:11], a[144:147], v[132:135]
ds_read_b64_tr_b16 a[100:101], v24 offset:14336
v_mfma_f32_16x16x32_bf16 v[144:147], a[16:19], a[144:147], v[144:147]
ds_read_b64_tr_b16 a[102:103], v24 offset:14592
v_mfma_f32_16x16x32_bf16 v[144:147], a[20:23], a[148:151], v[144:147]
ds_read_b64_tr_b16 a[104:105], v25 offset:2048
v_mfma_f32_16x16x32_bf16 v[148:151], a[28:31], a[148:151], v[148:151]
buffer_load_dwordx4 v15, s[12:15], s31 offen offset:1024  lds
v_mfma_f32_16x16x32_bf16 v[148:151], a[24:27], a[144:147], v[148:151]
ds_read_b64_tr_b16 a[106:107], v25 offset:2304
v_mfma_f32_16x16x32_bf16 v[156:159], a[24:27], a[152:155], v[156:159]
ds_read_b64_tr_b16 a[108:109], v25 offset:14336
v_mfma_f32_16x16x32_bf16 v[156:159], a[28:31], a[156:159], v[156:159]
ds_read_b64_tr_b16 a[110:111], v25 offset:14592
v_mfma_f32_16x16x32_bf16 v[152:155], a[20:23], a[156:159], v[152:155]
ds_read_b64_tr_b16 a[64:65], v24 offset:0
v_mfma_f32_16x16x32_bf16 v[152:155], a[16:19], a[152:155], v[152:155]
ds_read_b64_tr_b16 a[66:67], v24 offset:256
v_mfma_f32_16x16x32_bf16 v[140:143], a[8:11], a[152:155], v[140:143]
buffer_load_dwordx4 v16, s[12:15], s31 offen offset:2048  lds
v_mfma_f32_16x16x32_bf16 v[140:143], a[12:15], a[156:159], v[140:143]
ds_read_b64_tr_b16 a[68:69], v24 offset:12288
v_mfma_f32_16x16x32_bf16 v[136:139], a[4:7], a[156:159], v[136:139]
ds_read_b64_tr_b16 a[70:71], v24 offset:12544
v_mfma_f32_16x16x32_bf16 v[136:139], a[0:3], a[152:155], v[136:139]
ds_read_b64_tr_b16 a[72:73], v25 offset:0
v_mfma_f32_16x16x32_bf16 v[64:67], a[112:115], a[0:3], v[64:67]
ds_read_b64_tr_b16 a[74:75], v25 offset:256
v_mfma_f32_16x16x32_bf16 v[64:67], a[116:119], a[4:7], v[64:67]
s_add_u32 m0, s28, 27648
ds_read_b64_tr_b16 a[76:77], v25 offset:12288
v_mfma_f32_16x16x32_bf16 v[72:75], a[116:119], a[12:15], v[72:75]
buffer_load_dwordx4 v17, s[12:15], s31 offen offset:0  lds
v_mfma_f32_16x16x32_bf16 v[72:75], a[112:115], a[8:11], v[72:75]
ds_read_b64_tr_b16 a[78:79], v25 offset:12544
v_mfma_f32_16x16x32_bf16 v[80:83], a[112:115], a[16:19], v[80:83]
v_mfma_f32_16x16x32_bf16 v[80:83], a[116:119], a[20:23], v[80:83]
v_mfma_f32_16x16x32_bf16 v[88:91], a[116:119], a[28:31], v[88:91]
v_mfma_f32_16x16x32_bf16 v[88:91], a[112:115], a[24:27], v[88:91]
s_waitcnt vmcnt(14) lgkmcnt(0)
s_barrier
v_mfma_f32_16x16x32_bf16 v[92:95], a[120:123], a[24:27], v[92:95]
buffer_load_dwordx4 v18, s[12:15], s31 offen offset:1024  lds
v_mfma_f32_16x16x32_bf16 v[92:95], a[124:127], a[28:31], v[92:95]
v_lshlrev_b32 v52, 16, v50
v_lshlrev_b32 v47, 16, v51
v_mfma_f32_16x16x32_bf16 v[84:87], a[124:127], a[20:23], v[84:87]
v_and_b32 v50, 0xffff0000, v50
v_fmac_f32 v1, v52, v47
v_mfma_f32_16x16x32_bf16 v[84:87], a[120:123], a[16:19], v[84:87]
v_and_b32 v47, 0xffff0000, v51
v_fmac_f32 v1, v50, v47
v_mfma_f32_16x16x32_bf16 v[76:79], a[120:123], a[8:11], v[76:79]
v_add_u32 v49, 128, v49
v_mfma_f32_16x16x32_bf16 v[76:79], a[124:127], a[12:15], v[76:79]
v_mfma_f32_16x16x32_bf16 v[68:71], a[124:127], a[4:7], v[68:71]
buffer_load_dwordx4 v19, s[12:15], s31 offen offset:2048  lds
s_add_u32 s31, s31, 393216
v_mfma_f32_16x16x32_bf16 v[68:71], a[120:123], a[0:3], v[68:71]
v_mfma_f32_16x16x32_bf16 v[192:195], a[80:83], a[32:35], v[192:195]
ds_read_b64_tr_b16 a[128:129], v24 offset:25600
v_mfma_f32_16x16x32_bf16 v[192:195], a[84:87], a[36:39], v[192:195]
ds_read_b64_tr_b16 a[130:131], v24 offset:25856
v_mfma_f32_16x16x32_bf16 v[200:203], a[84:87], a[44:47], v[200:203]
ds_read_b64_tr_b16 a[132:133], v24 offset:37888
v_mfma_f32_16x16x32_bf16 v[200:203], a[80:83], a[40:43], v[200:203]
s_add_u32 m0, s28, 49152
ds_read_b64_tr_b16 a[134:135], v24 offset:38144
v_mfma_f32_16x16x32_bf16 v[208:211], a[80:83], a[48:51], v[208:211]
buffer_load_dwordx4 v14, s[40:43], s31 offen offset:0  lds
v_mfma_f32_16x16x32_bf16 v[208:211], a[84:87], a[52:55], v[208:211]
ds_read_b64_tr_b16 a[136:137], v25 offset:25600
v_mfma_f32_16x16x32_bf16 v[216:219], a[84:87], a[60:63], v[216:219]
ds_read_b64_tr_b16 a[138:139], v25 offset:25856
v_mfma_f32_16x16x32_bf16 v[216:219], a[80:83], a[56:59], v[216:219]
ds_read_b64_tr_b16 a[140:141], v25 offset:37888
v_mfma_f32_16x16x32_bf16 v[220:223], a[88:91], a[56:59], v[220:223]
ds_read_b64_tr_b16 a[142:143], v25 offset:38144
v_mfma_f32_16x16x32_bf16 v[220:223], a[92:95], a[60:63], v[220:223]
ds_read_b64_tr_b16 a[144:145], v24 offset:26624
v_mfma_f32_16x16x32_bf16 v[212:215], a[92:95], a[52:55], v[212:215]
buffer_load_dwordx4 v15, s[40:43], s31 offen offset:1024  lds
v_mfma_f32_16x16x32_bf16 v[212:215], a[88:91], a[48:51], v[212:215]
ds_read_b64_tr_b16 a[146:147], v24 offset:26880
v_mfma_f32_16x16x32_bf16 v[204:207], a[88:91], a[40:43], v[204:207]
ds_read_b64_tr_b16 a[148:149], v24 offset:38912
v_mfma_f32_16x16x32_bf16 v[204:207], a[92:95], a[44:47], v[204:207]
ds_read_b64_tr_b16 a[150:151], v24 offset:39168
v_mfma_f32_16x16x32_bf16 v[196:199], a[92:95], a[36:39], v[196:199]
ds_read_b64_tr_b16 a[152:153], v25 offset:26624
v_mfma_f32_16x16x32_bf16 v[196:199], a[88:91], a[32:35], v[196:199]
ds_read_b64_tr_b16 a[154:155], v25 offset:26880
v_mfma_f32_16x16x32_bf16 v[224:227], a[32:35], a[96:99], v[224:227]
buffer_load_dwordx4 v16, s[40:43], s31 offen offset:2048  lds
v_mfma_f32_16x16x32_bf16 v[224:227], a[36:39], a[100:103], v[224:227]
ds_read_b64_tr_b16 a[156:157], v25 offset:38912
v_mfma_f32_16x16x32_bf16 v[228:231], a[44:47], a[100:103], v[228:231]
ds_read_b64_tr_b16 a[158:159], v25 offset:39168
v_mfma_f32_16x16x32_bf16 v[228:231], a[40:43], a[96:99], v[228:231]
ds_read_b64_tr_b16 a[112:113], v24 offset:24576
v_mfma_f32_16x16x32_bf16 v[240:243], a[48:51], a[96:99], v[240:243]
ds_read_b64_tr_b16 a[114:115], v24 offset:24832
v_mfma_f32_16x16x32_bf16 v[240:243], a[52:55], a[100:103], v[240:243]
s_add_u32 m0, s28, 52224
ds_read_b64_tr_b16 a[116:117], v24 offset:36864
v_mfma_f32_16x16x32_bf16 v[244:247], a[60:63], a[100:103], v[244:247]
buffer_load_dwordx4 v17, s[40:43], s31 offen offset:0  lds
v_mfma_f32_16x16x32_bf16 v[244:247], a[56:59], a[96:99], v[244:247]
ds_read_b64_tr_b16 a[118:119], v24 offset:37120
v_mfma_f32_16x16x32_bf16 v[252:255], a[56:59], a[104:107], v[252:255]
ds_read_b64_tr_b16 a[120:121], v25 offset:24576
v_mfma_f32_16x16x32_bf16 v[252:255], a[60:63], a[108:111], v[252:255]
ds_read_b64_tr_b16 a[122:123], v25 offset:24832
v_mfma_f32_16x16x32_bf16 v[248:251], a[52:55], a[108:111], v[248:251]
ds_read_b64_tr_b16 a[124:125], v25 offset:36864
v_mfma_f32_16x16x32_bf16 v[248:251], a[48:51], a[104:107], v[248:251]
ds_read_b64_tr_b16 a[126:127], v25 offset:37120
v_mfma_f32_16x16x32_bf16 v[236:239], a[40:43], a[104:107], v[236:239]
buffer_load_dwordx4 v18, s[40:43], s31 offen offset:1024  lds
v_mfma_f32_16x16x32_bf16 v[236:239], a[44:47], a[108:111], v[236:239]
v_mfma_f32_16x16x32_bf16 v[232:235], a[36:39], a[108:111], v[232:235]
v_mfma_f32_16x16x32_bf16 v[232:235], a[32:35], a[104:107], v[232:235]
v_mfma_f32_16x16x32_bf16 v[160:163], a[64:67], a[32:35], v[160:163]
v_mfma_f32_16x16x32_bf16 v[160:163], a[68:71], a[36:39], v[160:163]
v_mfma_f32_16x16x32_bf16 v[168:171], a[68:71], a[44:47], v[168:171]
buffer_load_dwordx4 v19, s[40:43], s31 offen offset:2048  lds
v_mfma_f32_16x16x32_bf16 v[168:171], a[64:67], a[40:43], v[168:171]
v_mfma_f32_16x16x32_bf16 v[176:179], a[64:67], a[48:51], v[176:179]
buffer_load_dword v31, v29, s[52:55], 0 offen sc1
v_mfma_f32_16x16x32_bf16 v[176:179], a[68:71], a[52:55], v[176:179]
buffer_load_dword v0, v9, s[16:19], s60 offen
v_mfma_f32_16x16x32_bf16 v[184:187], a[68:71], a[60:63], v[184:187]
v_mfma_f32_16x16x32_bf16 v[184:187], a[64:67], a[56:59], v[184:187]
s_add_u32 m0, s27, 16384
s_waitcnt vmcnt(14) lgkmcnt(0)
s_barrier
v_mfma_f32_16x16x32_bf16 v[188:191], a[72:75], a[56:59], v[188:191]
buffer_load_dwordx4 v10, s[8:11], s30 offen offset:0  lds
v_mfma_f32_16x16x32_bf16 v[188:191], a[76:79], a[60:63], v[188:191]
ds_read_b32 v50, v48 offset:0
v_mfma_f32_16x16x32_bf16 v[180:183], a[76:79], a[52:55], v[180:183]
ds_read_b128 a[0:3], v20 offset:0
v_mfma_f32_16x16x32_bf16 v[180:183], a[72:75], a[48:51], v[180:183]
ds_read_b128 a[4:7], v21 offset:0
v_mfma_f32_16x16x32_bf16 v[172:175], a[72:75], a[40:43], v[172:175]
ds_read_b128 a[8:11], v20 offset:2048
v_mfma_f32_16x16x32_bf16 v[172:175], a[76:79], a[44:47], v[172:175]
buffer_load_dwordx4 v11, s[8:11], s30 offen offset:1024  lds
v_mfma_f32_16x16x32_bf16 v[164:167], a[76:79], a[36:39], v[164:167]
ds_read_b128 a[12:15], v21 offset:2048
v_mfma_f32_16x16x32_bf16 v[164:167], a[72:75], a[32:35], v[164:167]
ds_read_b128 a[16:19], v20 offset:4096
v_mfma_f32_16x16x32_bf16 v[96:99], a[32:35], a[128:131], v[96:99]
ds_read_b128 a[20:23], v21 offset:4096
v_mfma_f32_16x16x32_bf16 v[96:99], a[36:39], a[132:135], v[96:99]
ds_read_b128 a[24:27], v20 offset:6144
v_mfma_f32_16x16x32_bf16 v[100:103], a[44:47], a[132:135], v[100:103]
buffer_load_dwordx4 v12, s[8:11], s30 offen offset:2048  lds
v_mfma_f32_16x16x32_bf16 v[100:103], a[40:43], a[128:131], v[100:103]
ds_read_b128 a[28:31], v21 offset:6144
v_mfma_f32_16x16x32_bf16 v[112:115], a[48:51], a[128:131], v[112:115]
ds_read_b64_tr_b16 a[80:81], v22 offset:1024
v_mfma_f32_16x16x32_bf16 v[112:115], a[52:55], a[132:135], v[112:115]
ds_read_b64_tr_b16 a[82:83], v22 offset:1280
v_mfma_f32_16x16x32_bf16 v[116:119], a[60:63], a[132:135], v[116:119]
ds_read_b64_tr_b16 a[84:85], v22 offset:13312
v_mfma_f32_16x16x32_bf16 v[116:119], a[56:59], a[128:131], v[116:119]
buffer_load_dwordx4 v13, s[8:11], s30 offen offset:3072  lds
s_add_u32 s30, s30, 128
v_mfma_f32_16x16x32_bf16 v[124:127], a[56:59], a[136:139], v[124:127]
ds_read_b64_tr_b16 a[86:87], v22 offset:13568
v_mfma_f32_16x16x32_bf16 v[124:127], a[60:63], a[140:143], v[124:127]
ds_read_b64_tr_b16 a[88:89], v23 offset:1024
v_mfma_f32_16x16x32_bf16 v[120:123], a[52:55], a[140:143], v[120:123]
ds_read_b64_tr_b16 a[90:91], v23 offset:1280
v_mfma_f32_16x16x32_bf16 v[120:123], a[48:51], a[136:139], v[120:123]
s_add_u32 m0, s28, 73728
ds_read_b64_tr_b16 a[92:93], v23 offset:13312
v_mfma_f32_16x16x32_bf16 v[108:111], a[40:43], a[136:139], v[108:111]
buffer_load_dwordx4 v14, s[12:15], s31 offen offset:0  lds
v_mfma_f32_16x16x32_bf16 v[108:111], a[44:47], a[140:143], v[108:111]
ds_read_b64_tr_b16 a[94:95], v23 offset:13568
v_mfma_f32_16x16x32_bf16 v[104:107], a[36:39], a[140:143], v[104:107]
ds_read_b64_tr_b16 a[96:97], v22 offset:2048
v_mfma_f32_16x16x32_bf16 v[104:107], a[32:35], a[136:139], v[104:107]
ds_read_b64_tr_b16 a[98:99], v22 offset:2304
v_mfma_f32_16x16x32_bf16 v[128:131], a[32:35], a[144:147], v[128:131]
ds_read_b64_tr_b16 a[100:101], v22 offset:14336
v_mfma_f32_16x16x32_bf16 v[128:131], a[36:39], a[148:151], v[128:131]
buffer_load_dwordx4 v15, s[12:15], s31 offen offset:1024  lds
v_mfma_f32_16x16x32_bf16 v[132:135], a[44:47], a[148:151], v[132:135]
ds_read_b64_tr_b16 a[102:103], v22 offset:14592
v_mfma_f32_16x16x32_bf16 v[132:135], a[40:43], a[144:147], v[132:135]
ds_read_b64_tr_b16 a[104:105], v23 offset:2048
v_mfma_f32_16x16x32_bf16 v[144:147], a[48:51], a[144:147], v[144:147]
ds_read_b64_tr_b16 a[106:107], v23 offset:2304
v_mfma_f32_16x16x32_bf16 v[144:147], a[52:55], a[148:151], v[144:147]
ds_read_b64_tr_b16 a[108:109], v23 offset:14336
v_mfma_f32_16x16x32_bf16 v[148:151], a[60:63], a[148:151], v[148:151]
buffer_load_dwordx4 v16, s[12:15], s31 offen offset:2048  lds
v_mfma_f32_16x16x32_bf16 v[148:151], a[56:59], a[144:147], v[148:151]
ds_read_b64_tr_b16 a[110:111], v23 offset:14592
v_mfma_f32_16x16x32_bf16 v[156:159], a[56:59], a[152:155], v[156:159]
ds_read_b64_tr_b16 a[64:65], v22 offset:0
v_mfma_f32_16x16x32_bf16 v[156:159], a[60:63], a[156:159], v[156:159]
ds_read_b64_tr_b16 a[66:67], v22 offset:256
v_mfma_f32_16x16x32_bf16 v[152:155], a[52:55], a[156:159], v[152:155]
s_add_u32 m0, s28, 76800
ds_read_b64_tr_b16 a[68:69], v22 offset:12288
v_mfma_f32_16x16x32_bf16 v[152:155], a[48:51], a[152:155], v[152:155]
buffer_load_dwordx4 v17, s[12:15], s31 offen offset:0  lds
v_mfma_f32_16x16x32_bf16 v[140:143], a[40:43], a[152:155], v[140:143]
ds_read_b64_tr_b16 a[70:71], v22 offset:12544
v_mfma_f32_16x16x32_bf16 v[140:143], a[44:47], a[156:159], v[140:143]
ds_read_b64_tr_b16 a[72:73], v23 offset:0
v_mfma_f32_16x16x32_bf16 v[136:139], a[36:39], a[156:159], v[136:139]
ds_read_b64_tr_b16 a[74:75], v23 offset:256
v_mfma_f32_16x16x32_bf16 v[136:139], a[32:35], a[152:155], v[136:139]
ds_read_b64_tr_b16 a[76:77], v23 offset:12288
v_mfma_f32_16x16x32_bf16 v[64:67], a[112:115], a[32:35], v[64:67]
buffer_load_dwordx4 v18, s[12:15], s31 offen offset:1024  lds
v_mfma_f32_16x16x32_bf16 v[64:67], a[116:119], a[36:39], v[64:67]
ds_read_b64_tr_b16 a[78:79], v23 offset:12544
v_mfma_f32_16x16x32_bf16 v[72:75], a[116:119], a[44:47], v[72:75]
v_mfma_f32_16x16x32_bf16 v[72:75], a[112:115], a[40:43], v[72:75]
v_mfma_f32_16x16x32_bf16 v[80:83], a[112:115], a[48:51], v[80:83]
v_mfma_f32_16x16x32_bf16 v[80:83], a[116:119], a[52:55], v[80:83]
buffer_load_dwordx4 v19, s[12:15], s31 offen offset:2048  lds
s_add_u32 s31, s31, 393216
v_mfma_f32_16x16x32_bf16 v[88:91], a[116:119], a[60:63], v[88:91]
v_mfma_f32_16x16x32_bf16 v[88:91], a[112:115], a[56:59], v[88:91]
s_xor_b32 s31, s20, 0
s_waitcnt vmcnt(18) lgkmcnt(0)
s_barrier
v_mfma_f32_16x16x32_bf16 v[92:95], a[120:123], a[56:59], v[92:95]
s_add_u32 m0, s71, 147456
v_lshlrev_b32 v52, 16, v50
v_lshlrev_b32 v47, 16, v44
v_mfma_f32_16x16x32_bf16 v[92:95], a[124:127], a[60:63], v[92:95]
buffer_load_dwordx4 v60, s[44:47], s31 offen offset:0  lds
v_mfma_f32_16x16x32_bf16 v[84:87], a[124:127], a[52:55], v[84:87]
v_and_b32 v50, 0xffff0000, v50
v_fmac_f32 v1, v52, v47
v_mfma_f32_16x16x32_bf16 v[84:87], a[120:123], a[48:51], v[84:87]
v_and_b32 v47, 0xffff0000, v44
v_fmac_f32 v1, v50, v47
v_mfma_f32_16x16x32_bf16 v[76:79], a[120:123], a[40:43], v[76:79]
v_add_u32 v49, 128, v49
v_mfma_f32_16x16x32_bf16 v[76:79], a[124:127], a[44:47], v[76:79]
buffer_load_dwordx4 v61, s[44:47], s31 offen offset:1024  lds
v_mfma_f32_16x16x32_bf16 v[68:71], a[124:127], a[36:39], v[68:71]
v_mfma_f32_16x16x32_bf16 v[68:71], a[120:123], a[32:35], v[68:71]
v_mfma_f32_16x16x32_bf16 v[192:195], a[80:83], a[0:3], v[192:195]
ds_read_b64_tr_b16 a[128:129], v22 offset:25600
v_accvgpr_read_b32 v12, a208
v_mfma_f32_16x16x32_bf16 v[192:195], a[84:87], a[4:7], v[192:195]
buffer_load_dwordx4 v62, s[44:47], s31 offen offset:2048  lds
v_mfma_f32_16x16x32_bf16 v[200:203], a[84:87], a[12:15], v[200:203]
ds_read_b64_tr_b16 a[130:131], v22 offset:25856
v_accvgpr_read_b32 v10, a209
v_mfma_f32_16x16x32_bf16 v[200:203], a[80:83], a[8:11], v[200:203]
ds_read_b64_tr_b16 a[132:133], v22 offset:37888
v_accvgpr_read_b32 v11, a210
v_mfma_f32_16x16x32_bf16 v[208:211], a[80:83], a[16:19], v[208:211]
ds_read_b64_tr_b16 a[134:135], v22 offset:38144
v_accvgpr_read_b32 v5, a211
v_mfma_f32_16x16x32_bf16 v[208:211], a[84:87], a[20:23], v[208:211]
buffer_load_dwordx4 v63, s[44:47], s31 offen offset:3072  lds
v_mfma_f32_16x16x32_bf16 v[216:219], a[84:87], a[28:31], v[216:219]
ds_read_b64_tr_b16 a[136:137], v23 offset:25600
v_accvgpr_read_b32 v7, a212
v_mfma_f32_16x16x32_bf16 v[216:219], a[80:83], a[24:27], v[216:219]
s_xor_b32 s31, s20, 131072
ds_read_b64_tr_b16 a[138:139], v23 offset:25856
v_mfma_f32_16x16x32_bf16 v[220:223], a[88:91], a[24:27], v[220:223]
s_add_u32 m0, s71, 131072
ds_read_b64_tr_b16 a[140:141], v23 offset:37888
v_mfma_f32_16x16x32_bf16 v[220:223], a[92:95], a[28:31], v[220:223]
buffer_load_dwordx4 v60, s[44:47], s31 offen offset:0  lds
v_mfma_f32_16x16x32_bf16 v[212:215], a[92:95], a[20:23], v[212:215]
ds_read_b64_tr_b16 a[142:143], v23 offset:38144
v_accvgpr_read_b32 v13, a208
v_mfma_f32_16x16x32_bf16 v[212:215], a[88:91], a[16:19], v[212:215]
ds_read_b64_tr_b16 a[144:145], v22 offset:26624
v_accvgpr_read_b32 v14, a208
v_mfma_f32_16x16x32_bf16 v[204:207], a[88:91], a[8:11], v[204:207]
ds_read_b64_tr_b16 a[146:147], v22 offset:26880
v_accvgpr_read_b32 v15, a208
v_mfma_f32_16x16x32_bf16 v[204:207], a[92:95], a[12:15], v[204:207]
buffer_load_dwordx4 v61, s[44:47], s31 offen offset:1024  lds
v_mfma_f32_16x16x32_bf16 v[196:199], a[92:95], a[4:7], v[196:199]
ds_read_b64_tr_b16 a[148:149], v22 offset:38912
v_mov_b32 v40, 0xb5c1a2a0
v_mfma_f32_16x16x32_bf16 v[196:199], a[88:91], a[0:3], v[196:199]
ds_read_b64_tr_b16 a[150:151], v22 offset:39168
v_mov_b32 v41, 0xb5c1a2a0
v_mfma_f32_16x16x32_bf16 v[224:227], a[0:3], a[96:99], v[224:227]
ds_read_b64_tr_b16 a[152:153], v23 offset:26624
v_mfma_f32_16x16x32_bf16 v[224:227], a[4:7], a[100:103], v[224:227]
buffer_load_dwordx4 v62, s[44:47], s31 offen offset:2048  lds
v_mfma_f32_16x16x32_bf16 v[228:231], a[12:15], a[100:103], v[228:231]
ds_read_b64_tr_b16 a[154:155], v23 offset:26880
v_mfma_f32_16x16x32_bf16 v[228:231], a[8:11], a[96:99], v[228:231]
ds_read_b64_tr_b16 a[156:157], v23 offset:38912
v_mfma_f32_16x16x32_bf16 v[240:243], a[16:19], a[96:99], v[240:243]
ds_read_b64_tr_b16 a[158:159], v23 offset:39168
v_mfma_f32_16x16x32_bf16 v[240:243], a[20:23], a[100:103], v[240:243]
buffer_load_dwordx4 v63, s[44:47], s31 offen offset:3072  lds
v_mfma_f32_16x16x32_bf16 v[244:247], a[28:31], a[100:103], v[244:247]
ds_read_b64_tr_b16 a[112:113], v22 offset:24576
v_mfma_f32_16x16x32_bf16 v[244:247], a[24:27], a[96:99], v[244:247]
ds_read_b64_tr_b16 a[114:115], v22 offset:24832
v_mfma_f32_16x16x32_bf16 v[252:255], a[24:27], a[104:107], v[252:255]
ds_read_b64_tr_b16 a[116:117], v22 offset:36864
v_mfma_f32_16x16x32_bf16 v[252:255], a[28:31], a[108:111], v[252:255]
buffer_load_dword v0, v27, s[16:19], s67 offen
s_add_u32 s67, s67, 6272
v_mfma_f32_16x16x32_bf16 v[248:251], a[20:23], a[108:111], v[248:251]
ds_read_b64_tr_b16 a[118:119], v22 offset:37120
v_mfma_f32_16x16x32_bf16 v[248:251], a[16:19], a[104:107], v[248:251]
ds_read_b64_tr_b16 a[120:121], v23 offset:24576
v_mfma_f32_16x16x32_bf16 v[236:239], a[8:11], a[104:107], v[236:239]
ds_read_b64_tr_b16 a[122:123], v23 offset:24832
v_mfma_f32_16x16x32_bf16 v[236:239], a[12:15], a[108:111], v[236:239]
buffer_load_dword v0, v27, s[16:19], s67 offen
s_add_u32 s67, s67, 6272
v_mfma_f32_16x16x32_bf16 v[232:235], a[4:7], a[108:111], v[232:235]
ds_read_b64_tr_b16 a[124:125], v23 offset:36864
v_mfma_f32_16x16x32_bf16 v[232:235], a[0:3], a[104:107], v[232:235]
ds_read_b64_tr_b16 a[126:127], v23 offset:37120
v_mfma_f32_16x16x32_bf16 v[160:163], a[64:67], a[0:3], v[160:163]
v_mfma_f32_16x16x32_bf16 v[160:163], a[68:71], a[4:7], v[160:163]
s_waitcnt vmcnt(21)
v_and_b32 v30, 0xff, v31
s_mul_i32 s25, s23, 49152
s_lshl_b32 s27, s29, 11
v_mfma_f32_16x16x32_bf16 v[168:171], a[68:71], a[12:15], v[168:171]
v_cmp_ne_u32 vcc, 16, v30
s_cbranch_vccnz ARM_spin
ARM_ok:
v_mfma_f32_16x16x32_bf16 v[168:171], a[64:67], a[8:11], v[168:171]
v_readlane_b32 s34, v31, s22
s_lshl_b32 s64, s64, 4
s_add_u32 s27, s27, s25
v_mfma_f32_16x16x32_bf16 v[176:179], a[64:67], a[16:19], v[176:179]
s_cmp_eq_u32 s34, s64
s_cselect_b32 s35, 0, -1
s_add_u32 s67, s66, 4096
v_mfma_f32_16x16x32_bf16 v[176:179], a[68:71], a[20:23], v[176:179]
s_add_u32 s68, s66, 8192
s_add_u32 s69, s66, 12288
s_lshl_b32 s37, s36, 7
v_mfma_f32_16x16x32_bf16 v[184:187], a[68:71], a[28:31], v[184:187]
s_add_u32 s37, s37, 8519680
s_mul_i32 s3, s36, 401408
s_add_u32 s3, s3, 8523776
v_mfma_f32_16x16x32_bf16 v[184:187], a[64:67], a[24:27], v[184:187]
s_waitcnt vmcnt(16) lgkmcnt(0)
s_barrier
v_mfma_f32_16x16x32_bf16 v[188:191], a[72:75], a[24:27], v[188:191]
ds_read_b32 v50, v48 offset:16384
s_mul_i32 s28, s21, 25088
v_mfma_f32_16x16x32_bf16 v[188:191], a[76:79], a[28:31], v[188:191]
ds_read_b128 a[32:35], v20 offset:16384
s_add_u32 s28, s28, s3
v_mfma_f32_16x16x32_bf16 v[180:183], a[76:79], a[20:23], v[180:183]
ds_read_b128 a[36:39], v21 offset:16384
s_lshl_b32 s25, s29, 11
v_mfma_f32_16x16x32_bf16 v[180:183], a[72:75], a[16:19], v[180:183]
ds_read_b128 a[40:43], v20 offset:18432
s_add_u32 s28, s28, s25
v_mfma_f32_16x16x32_bf16 v[172:175], a[72:75], a[8:11], v[172:175]
ds_read_b128 a[44:47], v21 offset:18432
s_sub_u32 s28, s28, 8448
v_mfma_f32_16x16x32_bf16 v[172:175], a[76:79], a[12:15], v[172:175]
ds_read_b128 a[48:51], v20 offset:20480
s_sub_u32 s39, s28, 25088
v_mfma_f32_16x16x32_bf16 v[164:167], a[76:79], a[4:7], v[164:167]
ds_read_b128 a[52:55], v21 offset:20480
v_mfma_f32_16x16x32_bf16 v[164:167], a[72:75], a[0:3], v[164:167]
ds_read_b128 a[56:59], v20 offset:22528
v_mfma_f32_16x16x32_bf16 v[96:99], a[0:3], a[128:131], v[96:99]
ds_read_b128 a[60:63], v21 offset:22528
v_mfma_f32_16x16x32_bf16 v[96:99], a[4:7], a[132:135], v[96:99]
ds_read_b64_tr_b16 a[80:81], v24 offset:1024
v_mfma_f32_16x16x32_bf16 v[100:103], a[12:15], a[132:135], v[100:103]
ds_read_b64_tr_b16 a[82:83], v24 offset:1280
s_waitcnt lgkmcnt(8)
v_lshlrev_b32 v52, 16, v50
v_mfma_f32_16x16x32_bf16 v[100:103], a[8:11], a[128:131], v[100:103]
ds_read_b64_tr_b16 a[84:85], v24 offset:13312
v_lshlrev_b32 v47, 16, v43
v_mfma_f32_16x16x32_bf16 v[112:115], a[16:19], a[128:131], v[112:115]
ds_read_b64_tr_b16 a[86:87], v24 offset:13568
v_and_b32 v50, 0xffff0000, v50
v_mfma_f32_16x16x32_bf16 v[112:115], a[20:23], a[132:135], v[112:115]
ds_read_b64_tr_b16 a[88:89], v25 offset:1024
v_fmac_f32 v1, v52, v47
v_mfma_f32_16x16x32_bf16 v[116:119], a[28:31], a[132:135], v[116:119]
ds_read_b64_tr_b16 a[90:91], v25 offset:1280
v_and_b32 v47, 0xffff0000, v43
v_mfma_f32_16x16x32_bf16 v[116:119], a[24:27], a[128:131], v[116:119]
ds_read_b64_tr_b16 a[92:93], v25 offset:13312
v_fmac_f32 v1, v50, v47
v_mfma_f32_16x16x32_bf16 v[124:127], a[24:27], a[136:139], v[124:127]
ds_read_b64_tr_b16 a[94:95], v25 offset:13568
v_add_f32_dpp v1, v1, v1 row_ror:8 row_mask:0xf bank_mask:0xf
v_mfma_f32_16x16x32_bf16 v[124:127], a[28:31], a[140:143], v[124:127]
ds_read_b64_tr_b16 a[96:97], v24 offset:2048
v_mfma_f32_16x16x32_bf16 v[120:123], a[20:23], a[140:143], v[120:123]
ds_read_b64_tr_b16 a[98:99], v24 offset:2304
v_add_f32_dpp v1, v1, v1 row_ror:4 row_mask:0xf bank_mask:0xf
v_mfma_f32_16x16x32_bf16 v[120:123], a[16:19], a[136:139], v[120:123]
ds_read_b64_tr_b16 a[100:101], v24 offset:14336
v_mfma_f32_16x16x32_bf16 v[108:111], a[8:11], a[136:139], v[108:111]
ds_read_b64_tr_b16 a[102:103], v24 offset:14592
v_add_f32_dpp v1, v1, v1 row_ror:2 row_mask:0xf bank_mask:0xf
v_mfma_f32_16x16x32_bf16 v[108:111], a[12:15], a[140:143], v[108:111]
ds_read_b64_tr_b16 a[104:105], v25 offset:2048
v_mfma_f32_16x16x32_bf16 v[104:107], a[4:7], a[140:143], v[104:107]
ds_read_b64_tr_b16 a[106:107], v25 offset:2304
v_add_f32_dpp v1, v1, v1 row_ror:1 row_mask:0xf bank_mask:0xf
v_mfma_f32_16x16x32_bf16 v[104:107], a[0:3], a[136:139], v[104:107]
ds_read_b64_tr_b16 a[108:109], v25 offset:14336
v_mfma_f32_16x16x32_bf16 v[128:131], a[0:3], a[144:147], v[128:131]
ds_read_b64_tr_b16 a[110:111], v25 offset:14592
v_add_f32_dpp v1, v1, v1 row_bcast:15 row_mask:0xa bank_mask:0xf
v_mfma_f32_16x16x32_bf16 v[128:131], a[4:7], a[148:151], v[128:131]
ds_read_b64_tr_b16 a[64:65], v24 offset:0
v_mfma_f32_16x16x32_bf16 v[132:135], a[12:15], a[148:151], v[132:135]
ds_read_b64_tr_b16 a[66:67], v24 offset:256
v_mul_f32 v1, 0xbfb8aa3b, v1
v_mfma_f32_16x16x32_bf16 v[132:135], a[8:11], a[144:147], v[132:135]
ds_read_b64_tr_b16 a[68:69], v24 offset:12288
v_mfma_f32_16x16x32_bf16 v[144:147], a[16:19], a[144:147], v[144:147]
ds_read_b64_tr_b16 a[70:71], v24 offset:12544
v_mfma_f32_16x16x32_bf16 v[144:147], a[20:23], a[148:151], v[144:147]
ds_read_b64_tr_b16 a[72:73], v25 offset:0
v_mfma_f32_16x16x32_bf16 v[148:151], a[28:31], a[148:151], v[148:151]
ds_read_b64_tr_b16 a[74:75], v25 offset:256
v_mfma_f32_16x16x32_bf16 v[148:151], a[24:27], a[144:147], v[148:151]
ds_read_b64_tr_b16 a[76:77], v25 offset:12288
v_mfma_f32_16x16x32_bf16 v[156:159], a[24:27], a[152:155], v[156:159]
ds_read_b64_tr_b16 a[78:79], v25 offset:12544
v_mfma_f32_16x16x32_bf16 v[156:159], a[28:31], a[156:159], v[156:159]
v_exp_f32 v1, v1
s_cmp_lt_u32 s21, 1
s_cselect_b32 s28, 0x40000000, s28
v_mfma_f32_16x16x32_bf16 v[152:155], a[20:23], a[156:159], v[152:155]
v_add_f32 v1, 1.0, v1
s_cmp_lt_u32 s21, 2
s_cselect_b32 s39, 0x40000000, s39
v_mfma_f32_16x16x32_bf16 v[152:155], a[16:19], a[152:155], v[152:155]
v_rcp_f32 v44, v1
s_lshl_b32 s62, s61, 18
s_lshl_b32 s25, s36, 12
v_mfma_f32_16x16x32_bf16 v[140:143], a[8:11], a[152:155], v[140:143]
buffer_store_dwordx2 v[44:45], v46, s[16:19], s101 offen sc1
s_add_u32 s62, s62, s25
v_mfma_f32_16x16x32_bf16 v[140:143], a[12:15], a[156:159], v[140:143]
s_xor_b32 s63, s62, 131072
s_lshl_b32 s38, s26, 12
s_add_u32 s38, s38, 8388608
v_mfma_f32_16x16x32_bf16 v[136:139], a[4:7], a[156:159], v[136:139]
s_lshl_b32 s65, s24, 11
s_lshl_b32 s21, s26, 18
s_add_u32 s21, s21, s65
v_mfma_f32_16x16x32_bf16 v[136:139], a[0:3], a[152:155], v[136:139]
s_lshr_b32 s25, s20, 4
s_add_u32 s21, s21, s25
s_xor_b32 s30, s21, 0
v_mfma_f32_16x16x32_bf16 v[64:67], a[112:115], a[0:3], v[64:67]
s_mov_b32 s4, 0x3fb8aa3b
s_mov_b32 s5, s4
s_mov_b32 s6, 0x3e8293ee
v_mfma_f32_16x16x32_bf16 v[64:67], a[116:119], a[4:7], v[64:67]
s_mov_b32 s7, s6
s_cmp_ge_u32 s61, 1
s_cselect_b32 s12, -1, 0
v_mfma_f32_16x16x32_bf16 v[72:75], a[116:119], a[12:15], v[72:75]
s_cmp_ge_u32 s61, 2
s_cselect_b32 s13, -1, 0
v_mfma_f32_16x16x32_bf16 v[72:75], a[112:115], a[8:11], v[72:75]
s_cmp_ge_u32 s61, 3
s_cselect_b32 s14, -1, 0
v_mfma_f32_16x16x32_bf16 v[80:83], a[112:115], a[16:19], v[80:83]
s_cmp_ge_u32 s61, 4
s_cselect_b32 s15, -1, 0
v_mfma_f32_16x16x32_bf16 v[80:83], a[116:119], a[20:23], v[80:83]
v_mfma_f32_16x16x32_bf16 v[88:91], a[116:119], a[28:31], v[88:91]
v_mfma_f32_16x16x32_bf16 v[88:91], a[112:115], a[24:27], v[88:91]
s_waitcnt vmcnt(11) lgkmcnt(0)
s_barrier
v_mfma_f32_16x16x32_bf16 v[92:95], a[120:123], a[24:27], v[92:95]
v_mfma_f32_16x16x32_bf16 v[92:95], a[124:127], a[28:31], v[92:95]
v_mfma_f32_16x16x32_bf16 v[84:87], a[124:127], a[20:23], v[84:87]
v_mfma_f32_16x16x32_bf16 v[84:87], a[120:123], a[16:19], v[84:87]
v_mfma_f32_16x16x32_bf16 v[76:79], a[120:123], a[8:11], v[76:79]
v_mfma_f32_16x16x32_bf16 v[76:79], a[124:127], a[12:15], v[76:79]
v_mfma_f32_16x16x32_bf16 v[68:71], a[124:127], a[4:7], v[68:71]
v_mfma_f32_16x16x32_bf16 v[68:71], a[120:123], a[0:3], v[68:71]
v_mfma_f32_16x16x32_bf16 v[192:195], a[80:83], a[32:35], v[192:195]
ds_read_b64_tr_b16 a[128:129], v24 offset:25600
v_mfma_f32_16x16x32_bf16 v[192:195], a[84:87], a[36:39], v[192:195]
ds_read_b64_tr_b16 a[130:131], v24 offset:25856
v_mfma_f32_16x16x32_bf16 v[200:203], a[84:87], a[44:47], v[200:203]
ds_read_b64_tr_b16 a[132:133], v24 offset:37888
v_mfma_f32_16x16x32_bf16 v[200:203], a[80:83], a[40:43], v[200:203]
ds_read_b64_tr_b16 a[134:135], v24 offset:38144
v_mfma_f32_16x16x32_bf16 v[208:211], a[80:83], a[48:51], v[208:211]
ds_read_b64_tr_b16 a[136:137], v25 offset:25600
v_mfma_f32_16x16x32_bf16 v[208:211], a[84:87], a[52:55], v[208:211]
ds_read_b64_tr_b16 a[138:139], v25 offset:25856
v_mfma_f32_16x16x32_bf16 v[216:219], a[84:87], a[60:63], v[216:219]
ds_read_b64_tr_b16 a[140:141], v25 offset:37888
v_mfma_f32_16x16x32_bf16 v[216:219], a[80:83], a[56:59], v[216:219]
ds_read_b64_tr_b16 a[142:143], v25 offset:38144
v_mfma_f32_16x16x32_bf16 v[220:223], a[88:91], a[56:59], v[220:223]
ds_read_b64_tr_b16 a[144:145], v24 offset:26624
v_mfma_f32_16x16x32_bf16 v[220:223], a[92:95], a[60:63], v[220:223]
ds_read_b64_tr_b16 a[146:147], v24 offset:26880
v_mfma_f32_16x16x32_bf16 v[212:215], a[92:95], a[52:55], v[212:215]
ds_read_b64_tr_b16 a[148:149], v24 offset:38912
v_mfma_f32_16x16x32_bf16 v[212:215], a[88:91], a[48:51], v[212:215]
ds_read_b64_tr_b16 a[150:151], v24 offset:39168
v_mfma_f32_16x16x32_bf16 v[204:207], a[88:91], a[40:43], v[204:207]
ds_read_b64_tr_b16 a[152:153], v25 offset:26624
v_mfma_f32_16x16x32_bf16 v[204:207], a[92:95], a[44:47], v[204:207]
ds_read_b64_tr_b16 a[154:155], v25 offset:26880
v_mfma_f32_16x16x32_bf16 v[196:199], a[92:95], a[36:39], v[196:199]
ds_read_b64_tr_b16 a[156:157], v25 offset:38912
v_mfma_f32_16x16x32_bf16 v[196:199], a[88:91], a[32:35], v[196:199]
ds_read_b64_tr_b16 a[158:159], v25 offset:39168
v_mfma_f32_16x16x32_bf16 v[224:227], a[32:35], a[96:99], v[224:227]
ds_read_b64_tr_b16 a[112:113], v24 offset:24576
v_mfma_f32_16x16x32_bf16 v[224:227], a[36:39], a[100:103], v[224:227]
ds_read_b64_tr_b16 a[114:115], v24 offset:24832
v_mfma_f32_16x16x32_bf16 v[228:231], a[44:47], a[100:103], v[228:231]
ds_read_b64_tr_b16 a[116:117], v24 offset:36864
v_mfma_f32_16x16x32_bf16 v[228:231], a[40:43], a[96:99], v[228:231]
ds_read_b64_tr_b16 a[118:119], v24 offset:37120
v_mfma_f32_16x16x32_bf16 v[240:243], a[48:51], a[96:99], v[240:243]
ds_read_b64_tr_b16 a[120:121], v25 offset:24576
v_mfma_f32_16x16x32_bf16 v[240:243], a[52:55], a[100:103], v[240:243]
ds_read_b64_tr_b16 a[122:123], v25 offset:24832
v_mfma_f32_16x16x32_bf16 v[244:247], a[60:63], a[100:103], v[244:247]
ds_read_b64_tr_b16 a[124:125], v25 offset:36864
v_mfma_f32_16x16x32_bf16 v[244:247], a[56:59], a[96:99], v[244:247]
ds_read_b64_tr_b16 a[126:127], v25 offset:37120
v_mfma_f32_16x16x32_bf16 v[252:255], a[56:59], a[104:107], v[252:255]
v_mfma_f32_16x16x32_bf16 v[252:255], a[60:63], a[108:111], v[252:255]
v_mfma_f32_16x16x32_bf16 v[248:251], a[52:55], a[108:111], v[248:251]
v_mfma_f32_16x16x32_bf16 v[248:251], a[48:51], a[104:107], v[248:251]
v_mfma_f32_16x16x32_bf16 v[236:239], a[40:43], a[104:107], v[236:239]
v_mfma_f32_16x16x32_bf16 v[236:239], a[44:47], a[108:111], v[236:239]
v_mfma_f32_16x16x32_bf16 v[232:235], a[36:39], a[108:111], v[232:235]
v_mfma_f32_16x16x32_bf16 v[232:235], a[32:35], a[104:107], v[232:235]
s_waitcnt lgkmcnt(0)
s_barrier
v_mfma_f32_16x16x32_bf16 v[96:99], a[32:35], a[128:131], v[96:99]
s_lshr_b32 s64, s61, 4
v_cvt_pk_bf16_f32 v192, v192, v193
v_cvt_pk_bf16_f32 v193, v194, v195
v_mfma_f32_16x16x32_bf16 v[96:99], a[36:39], a[132:135], v[96:99]
s_lshl_b32 s64, s64, 1
v_cvt_pk_bf16_f32 v194, v196, v197
v_cvt_pk_bf16_f32 v195, v198, v199
v_mfma_f32_16x16x32_bf16 v[100:103], a[44:47], a[132:135], v[100:103]
buffer_store_dwordx4 v[192:195], v5, s[16:19], s66 offen offset:0
ds_write_b128 v54, v[192:195] offset:0
s_add_u32 s64, s64, s29
s_bfe_u32 s9, s61, 0x30001
s_lshl_b32 s64, s64, 10
s_lshl_b32 s9, s9, 7
v_mfma_f32_16x16x32_bf16 v[100:103], a[40:43], a[128:131], v[100:103]
s_add_u32 s64, s64, s9
v_cvt_pk_bf16_f32 v200, v200, v201
v_cvt_pk_bf16_f32 v201, v202, v203
v_mfma_f32_16x16x32_bf16 v[112:115], a[48:51], a[128:131], v[112:115]
s_add_u32 s64, s64, s3
v_cvt_pk_bf16_f32 v202, v204, v205
v_cvt_pk_bf16_f32 v203, v206, v207
v_mfma_f32_16x16x32_bf16 v[112:115], a[52:55], a[132:135], v[112:115]
ds_write_b128 v54, v[200:203] offset:256
buffer_store_dwordx4 v[200:203], v5, s[16:19], s66 offen offset:256
s_add_u32 s8, s64, 8192
s_mul_i32 s10, s29, 12536
s_sub_u32 s10, s69, s10
s_xor_b32 s31, s20, 262144
v_mfma_f32_16x16x32_bf16 v[116:119], a[60:63], a[132:135], v[116:119]
v_cvt_pk_bf16_f32 v224, v224, v225
v_cvt_pk_bf16_f32 v225, v226, v227
v_mfma_f32_16x16x32_bf16 v[116:119], a[56:59], a[128:131], v[116:119]
v_cvt_pk_bf16_f32 v226, v228, v229
v_cvt_pk_bf16_f32 v227, v230, v231
v_mfma_f32_16x16x32_bf16 v[124:127], a[56:59], a[136:139], v[124:127]
ds_write_b128 v54, v[224:227] offset:2048
buffer_store_dwordx4 v[224:227], v5, s[16:19], s66 offen offset:2048
v_mfma_f32_16x16x32_bf16 v[124:127], a[60:63], a[140:143], v[124:127]
v_cvt_pk_bf16_f32 v232, v232, v233
v_cvt_pk_bf16_f32 v233, v234, v235
v_mfma_f32_16x16x32_bf16 v[120:123], a[52:55], a[140:143], v[120:123]
v_cvt_pk_bf16_f32 v234, v236, v237
v_cvt_pk_bf16_f32 v235, v238, v239
v_mfma_f32_16x16x32_bf16 v[120:123], a[48:51], a[136:139], v[120:123]
ds_write_b128 v54, v[232:235] offset:2304
v_mfma_f32_16x16x32_bf16 v[108:111], a[40:43], a[136:139], v[108:111]
buffer_store_dwordx4 v[232:235], v5, s[16:19], s66 offen offset:2304
v_mfma_f32_16x16x32_bf16 v[108:111], a[44:47], a[140:143], v[108:111]
v_cvt_pk_bf16_f32 v208, v208, v209
v_cvt_pk_bf16_f32 v209, v210, v211
v_mfma_f32_16x16x32_bf16 v[104:107], a[36:39], a[140:143], v[104:107]
v_cvt_pk_bf16_f32 v210, v212, v213
v_cvt_pk_bf16_f32 v211, v214, v215
v_mfma_f32_16x16x32_bf16 v[104:107], a[32:35], a[136:139], v[104:107]
ds_write_b128 v54, v[208:211] offset:4096
v_mfma_f32_16x16x32_bf16 v[128:131], a[32:35], a[144:147], v[128:131]
buffer_store_dwordx4 v[208:211], v5, s[16:19], s67 offen offset:0
v_mfma_f32_16x16x32_bf16 v[128:131], a[36:39], a[148:151], v[128:131]
v_cvt_pk_bf16_f32 v216, v216, v217
v_cvt_pk_bf16_f32 v217, v218, v219
v_mfma_f32_16x16x32_bf16 v[132:135], a[44:47], a[148:151], v[132:135]
v_cvt_pk_bf16_f32 v218, v220, v221
v_cvt_pk_bf16_f32 v219, v222, v223
v_mfma_f32_16x16x32_bf16 v[132:135], a[40:43], a[144:147], v[132:135]
ds_write_b128 v54, v[216:219] offset:4352
v_mfma_f32_16x16x32_bf16 v[144:147], a[48:51], a[144:147], v[144:147]
buffer_store_dwordx4 v[216:219], v5, s[16:19], s67 offen offset:256
v_mfma_f32_16x16x32_bf16 v[144:147], a[52:55], a[148:151], v[144:147]
v_cvt_pk_bf16_f32 v240, v240, v241
v_cvt_pk_bf16_f32 v241, v242, v243
v_mfma_f32_16x16x32_bf16 v[148:151], a[60:63], a[148:151], v[148:151]
s_waitcnt vmcnt(13)
v_cvt_pk_bf16_f32 v242, v244, v245
v_cvt_pk_bf16_f32 v243, v246, v247
v_mfma_f32_16x16x32_bf16 v[148:151], a[56:59], a[144:147], v[148:151]
ds_write_b128 v54, v[240:243] offset:6144
s_waitcnt vmcnt(9)
v_mfma_f32_16x16x32_bf16 v[156:159], a[56:59], a[152:155], v[156:159]
buffer_store_dwordx4 v[240:243], v5, s[16:19], s67 offen offset:2048
v_mfma_f32_16x16x32_bf16 v[156:159], a[60:63], a[156:159], v[156:159]
v_cvt_pk_bf16_f32 v248, v248, v249
v_cvt_pk_bf16_f32 v249, v250, v251
v_mfma_f32_16x16x32_bf16 v[152:155], a[52:55], a[156:159], v[152:155]
ds_read_b64_tr_b16 a[160:161], v58 offset:49152
v_cvt_pk_bf16_f32 v250, v252, v253
v_mfma_f32_16x16x32_bf16 v[152:155], a[48:51], a[152:155], v[152:155]
ds_read_b64_tr_b16 a[162:163], v58 offset:51200
v_cvt_pk_bf16_f32 v251, v254, v255
v_mfma_f32_16x16x32_bf16 v[140:143], a[40:43], a[152:155], v[140:143]
buffer_store_dwordx4 v[248:251], v5, s[16:19], s67 offen offset:2304
ds_write_b128 v54, v[248:251] offset:6400
v_mfma_f32_16x16x32_bf16 v[140:143], a[44:47], a[156:159], v[140:143]
v_cvt_pk_bf16_f32 v128, v128, v129
v_cvt_pk_bf16_f32 v129, v130, v131
v_mfma_f32_16x16x32_bf16 v[136:139], a[36:39], a[156:159], v[136:139]
ds_read_b64_tr_b16 a[164:165], v59 offset:49152
v_cvt_pk_bf16_f32 v144, v144, v145
v_mfma_f32_16x16x32_bf16 v[136:139], a[32:35], a[152:155], v[136:139]
s_add_u32 m0, s71, 98304
ds_read_b64_tr_b16 a[166:167], v59 offset:51200
buffer_load_dwordx4 v60, s[44:47], s31 offen offset:0  lds
ds_read_b64_tr_b16 a[168:169], v58 offset:49664
v_cvt_pk_bf16_f32 v130, v132, v133
v_pk_fma_f32 v[16:17], v[96:97], s[4:5], v[40:41]
v_pk_fma_f32 v[18:19], v[98:99], s[4:5], v[40:41]
v_pk_fma_f32 v[208:209], v[112:113], s[4:5], v[40:41]
v_pk_fma_f32 v[20:21], v[100:101], s[4:5], v[40:41]
v_pk_fma_f32 v[22:23], v[102:103], s[4:5], v[40:41]
v_exp_f32_e64 v16, v16 clamp
v_exp_f32_e64 v17, v17 clamp
v_pk_fma_f32 v[210:211], v[114:115], s[4:5], v[40:41]
v_pk_fma_f32 v[216:217], v[120:121], s[4:5], v[40:41]
v_max_f32 v96, s32, v96
v_max_f32 v97, s32, v97
v_exp_f32_e64 v18, v18 clamp
v_exp_f32_e64 v19, v19 clamp
v_pk_fma_f32 v[212:213], v[116:117], s[4:5], v[40:41]
v_pk_fma_f32 v[214:215], v[118:119], s[4:5], v[40:41]
v_exp_f32_e64 v208, v208 clamp
v_exp_f32_e64 v209, v209 clamp
v_pk_fma_f32 v[218:219], v[122:123], s[4:5], v[40:41]
v_max_f32 v98, s32, v98
v_max_f32 v99, s32, v99
v_exp_f32_e64 v20, v20 clamp
v_exp_f32_e64 v21, v21 clamp
v_exp_f32_e64 v22, v22 clamp
v_exp_f32_e64 v23, v23 clamp
v_max_f32 v112, s32, v112
v_max_f32 v113, s32, v113
v_exp_f32_e64 v210, v210 clamp
v_exp_f32_e64 v211, v211 clamp
v_pk_fma_f32 v[222:223], v[126:127], s[4:5], v[40:41]
v_exp_f32_e64 v216, v216 clamp
v_exp_f32_e64 v217, v217 clamp
v_max_f32 v100, s32, v100
v_max_f32 v101, s32, v101
v_max_f32 v102, s32, v102
v_max_f32 v103, s32, v103
v_pk_add_f32 v[96:97], v[96:97], v[16:17]
v_max_f32 v114, s32, v114
v_max_f32 v115, s32, v115
v_exp_f32_e64 v212, v212 clamp
v_exp_f32_e64 v213, v213 clamp
v_exp_f32_e64 v214, v214 clamp
v_exp_f32_e64 v215, v215 clamp
v_max_f32 v120, s32, v120
v_max_f32 v121, s32, v121
v_exp_f32_e64 v218, v218 clamp
v_exp_f32_e64 v219, v219 clamp
v_pk_add_f32 v[98:99], v[98:99], v[18:19]
v_max_f32 v116, s32, v116
v_max_f32 v117, s32, v117
v_max_f32 v118, s32, v118
v_max_f32 v119, s32, v119
v_pk_add_f32 v[112:113], v[112:113], v[208:209]
v_max_f32 v122, s32, v122
v_max_f32 v123, s32, v123
v_exp_f32_e64 v222, v222 clamp
v_exp_f32_e64 v223, v223 clamp
v_pk_add_f32 v[100:101], v[100:101], v[20:21]
v_pk_add_f32 v[102:103], v[102:103], v[22:23]
v_cvt_pk_bf16_f32 v96, v96, v97
v_pk_add_f32 v[114:115], v[114:115], v[210:211]
v_max_f32 v126, s32, v126
v_max_f32 v127, s32, v127
v_pk_add_f32 v[120:121], v[120:121], v[216:217]
v_cvt_pk_bf16_f32 v97, v98, v99
v_pk_add_f32 v[116:117], v[116:117], v[212:213]
v_pk_add_f32 v[118:119], v[118:119], v[214:215]
v_cvt_pk_bf16_f32 v112, v112, v113
v_pk_add_f32 v[122:123], v[122:123], v[218:219]
v_cvt_pk_bf16_f32 v131, v134, v135
v_cvt_pk_bf16_f32 v98, v100, v101
v_cvt_pk_bf16_f32 v99, v102, v103
v_cvt_pk_bf16_f32 v145, v146, v147
v_cvt_pk_bf16_f32 v113, v114, v115
v_pk_add_f32 v[126:127], v[126:127], v[222:223]
v_cvt_pk_bf16_f32 v120, v120, v121
v_cvt_pk_bf16_f32 v146, v148, v149
v_cvt_pk_bf16_f32 v147, v150, v151
v_cvt_pk_bf16_f32 v114, v116, v117
v_cvt_pk_bf16_f32 v115, v118, v119
v_cvt_pk_bf16_f32 v121, v122, v123
v_cvt_pk_bf16_f32 v123, v126, v127
v_mfma_f32_16x16x32_bf16 v[224:227], v[96:99], v[128:131], 0
buffer_load_dwordx4 v61, s[44:47], s31 offen offset:1024  lds
ds_read_b64_tr_b16 a[170:171], v58 offset:51712
ds_read_b64_tr_b16 a[172:173], v59 offset:49664
v_mfma_f32_16x16x32_bf16 v[224:227], v[112:115], v[144:147], v[224:227]
ds_read_b64_tr_b16 a[174:175], v59 offset:51712
v_cvt_pk_bf16_f32 v136, v136, v137
v_cvt_pk_bf16_f32 v137, v138, v139
v_cvt_pk_bf16_f32 v152, v152, v153
v_cvt_pk_bf16_f32 v138, v140, v141
v_cvt_pk_bf16_f32 v139, v142, v143
v_pk_fma_f32 v[24:25], v[104:105], s[4:5], v[40:41]
v_pk_fma_f32 v[26:27], v[106:107], s[4:5], v[40:41]
v_pk_fma_f32 v[28:29], v[108:109], s[4:5], v[40:41]
v_pk_fma_f32 v[30:31], v[110:111], s[4:5], v[40:41]
v_exp_f32_e64 v24, v24 clamp
v_exp_f32_e64 v25, v25 clamp
v_max_f32 v104, s32, v104
v_max_f32 v105, s32, v105
v_exp_f32_e64 v26, v26 clamp
v_exp_f32_e64 v27, v27 clamp
v_pk_fma_f32 v[220:221], v[124:125], s[4:5], v[40:41]
v_max_f32 v106, s32, v106
v_max_f32 v107, s32, v107
v_exp_f32_e64 v28, v28 clamp
v_exp_f32_e64 v29, v29 clamp
v_exp_f32_e64 v30, v30 clamp
v_exp_f32_e64 v31, v31 clamp
v_max_f32 v108, s32, v108
v_max_f32 v109, s32, v109
v_max_f32 v110, s32, v110
v_max_f32 v111, s32, v111
v_pk_add_f32 v[104:105], v[104:105], v[24:25]
v_exp_f32_e64 v220, v220 clamp
v_exp_f32_e64 v221, v221 clamp
v_pk_add_f32 v[106:107], v[106:107], v[26:27]
v_max_f32 v124, s32, v124
v_max_f32 v125, s32, v125
v_pk_add_f32 v[108:109], v[108:109], v[28:29]
v_pk_add_f32 v[110:111], v[110:111], v[30:31]
v_mov_b32 v1, 1
s_cmp_lg_u32 s35, 0
s_waitcnt vmcnt(2)
s_cbranch_scc1 S1_far
buffer_store_dword v1, v9, s[16:19], s60 offen
S1_done:
v_cvt_pk_bf16_f32 v104, v104, v105
buffer_store_dwordx4 v[224:227], v3, s[16:19], s68 offen offset:0
ds_read_b64_tr_b16 a[176:177], v58 offset:32768
v_cvt_pk_bf16_f32 v105, v106, v107
v_pk_add_f32 v[124:125], v[124:125], v[220:221]
v_cvt_pk_bf16_f32 v106, v108, v109
v_cvt_pk_bf16_f32 v107, v110, v111
v_cvt_pk_bf16_f32 v122, v124, v125
v_cvt_pk_bf16_f32 v153, v154, v155
v_mfma_f32_16x16x32_bf16 v[228:231], v[104:107], v[128:131], 0
ds_read_b64_tr_b16 a[178:179], v58 offset:34816
v_cvt_pk_bf16_f32 v154, v156, v157
v_mfma_f32_16x16x32_bf16 v[228:231], v[120:123], v[144:147], v[228:231]
ds_read_b64_tr_b16 a[180:181], v59 offset:32768
buffer_load_dwordx4 v62, s[44:47], s31 offen offset:2048  lds
ds_read_b64_tr_b16 a[182:183], v59 offset:34816
v_cvt_pk_bf16_f32 v155, v158, v159
v_mfma_f32_16x16x32_bf16 v[232:235], v[96:99], v[136:139], 0
ds_read_b64_tr_b16 a[184:185], v58 offset:33280
v_mov_b32 v48, 0x3f803f80
v_mfma_f32_16x16x32_bf16 v[232:235], v[112:115], v[152:155], v[232:235]
ds_read_b64_tr_b16 a[186:187], v58 offset:35328
buffer_store_dwordx4 v[228:231], v3, s[16:19], s68 offen offset:1024
ds_read_b64_tr_b16 a[188:189], v59 offset:33280
v_mfma_f32_16x16x32_bf16 v[236:239], v[104:107], v[136:139], 0
ds_read_b64_tr_b16 a[190:191], v59 offset:35328
v_mov_b32 v49, 0x3f803f80
v_mfma_f32_16x16x32_bf16 v[236:239], v[120:123], v[152:155], v[236:239]
ds_read_b128 v[224:227], v4 offset:34816
v_mov_b32 v50, 0x3f803f80
v_mov_b32 v51, 0x3f803f80
v_mfma_f32_16x16x32_bf16 v[160:163], a[64:67], a[32:35], v[160:163]
ds_read_b128 v[228:231], v4 offset:35840
buffer_store_dwordx4 v[232:235], v3, s[16:19], s68 offen offset:2048
v_mfma_f32_16x16x32_bf16 v[240:243], v[96:99], v[48:51], 0
v_mfma_f32_16x16x32_bf16 v[240:243], v[112:115], v[48:51], v[240:243]
v_mfma_f32_16x16x32_bf16 v[244:247], v[104:107], v[48:51], 0
buffer_store_dwordx4 v[236:239], v3, s[16:19], s68 offen offset:3072
v_mfma_f32_16x16x32_bf16 v[244:247], v[120:123], v[48:51], v[244:247]
v_mfma_f32_16x16x32_bf16 v[160:163], a[68:71], a[36:39], v[160:163]
v_mfma_f32_16x16x32_bf16 v[168:171], a[68:71], a[44:47], v[168:171]
v_mfma_f32_16x16x32_bf16 v[168:171], a[64:67], a[40:43], v[168:171]
s_nop 1
buffer_store_dwordx4 v[240:243], v53, s[16:19], s69 offen offset:0
s_nop 1
buffer_store_dwordx4 v[244:247], v53, s[16:19], s69 offen offset:16
v_mfma_f32_16x16x32_bf16 v[176:179], a[64:67], a[48:51], v[176:179]
buffer_load_dwordx4 v63, s[44:47], s31 offen offset:3072  lds
s_xor_b32 s31, s20, 393216
v_mfma_f32_16x16x32_bf16 v[176:179], a[68:71], a[52:55], v[176:179]
v_mfma_f32_16x16x32_bf16 v[184:187], a[68:71], a[60:63], v[184:187]
v_mfma_f32_16x16x32_bf16 v[184:187], a[64:67], a[56:59], v[184:187]
s_add_u32 m0, s71, 114688
buffer_load_dword v56, v42, s[16:19], s37 offen sc1
v_mfma_f32_16x16x32_bf16 v[188:191], a[72:75], a[56:59], v[188:191]
buffer_load_dwordx4 v60, s[44:47], s31 offen offset:0  lds
v_mfma_f32_16x16x32_bf16 v[188:191], a[76:79], a[60:63], v[188:191]
v_mfma_f32_16x16x32_bf16 v[180:183], a[76:79], a[52:55], v[180:183]
v_mfma_f32_16x16x32_bf16 v[180:183], a[72:75], a[48:51], v[180:183]
buffer_load_dwordx4 v61, s[44:47], s31 offen offset:1024  lds
v_mfma_f32_16x16x32_bf16 v[172:175], a[72:75], a[40:43], v[172:175]
v_mfma_f32_16x16x32_bf16 v[172:175], a[76:79], a[44:47], v[172:175]
v_mfma_f32_16x16x32_bf16 v[164:167], a[76:79], a[36:39], v[164:167]
buffer_load_dwordx4 v62, s[44:47], s31 offen offset:2048  lds
v_mfma_f32_16x16x32_bf16 v[164:167], a[72:75], a[32:35], v[164:167]
v_mfma_f32_16x16x32_bf16 v[64:67], a[112:115], a[32:35], v[64:67]
v_mfma_f32_16x16x32_bf16 v[64:67], a[116:119], a[36:39], v[64:67]
buffer_load_dwordx4 v63, s[44:47], s31 offen offset:3072  lds
s_xor_b32 s31, s20, 524288
v_mfma_f32_16x16x32_bf16 v[72:75], a[116:119], a[44:47], v[72:75]
v_mfma_f32_16x16x32_bf16 v[72:75], a[112:115], a[40:43], v[72:75]
s_add_u32 m0, s71, 147456
v_mfma_f32_16x16x32_bf16 v[80:83], a[112:115], a[48:51], v[80:83]
s_waitcnt lgkmcnt(0)
buffer_load_dwordx4 v60, s[44:47], s31 offen offset:0  lds
v_mov_b32 v1, 2
s_cmp_lg_u32 s35, 0
s_waitcnt vmcnt(7)
s_cbranch_scc1 S2_far
buffer_store_dword v1, v9, s[16:19], s60 offen
S2_done:
v_mfma_f32_16x16x32_bf16 v[80:83], a[116:119], a[52:55], v[80:83]
s_or_b32 s34, s35, 1
s_waitcnt vmcnt(6)
v_cmp_gt_u32 vcc, s34, v56
s_cbranch_vccnz P3_spin
P3_ok:
s_add_u32 m0, s27, 28672
v_mfma_f32_16x16x32_bf16 v[88:91], a[116:119], a[60:63], v[88:91]
buffer_load_dwordx4 v3, s[16:19], s28 offen offset:0 sc1 lds
v_mfma_f32_16x16x32_bf16 v[88:91], a[112:115], a[56:59], v[88:91]
v_mfma_f32_16x16x32_bf16 v[92:95], a[120:123], a[56:59], v[92:95]
v_mfma_f32_16x16x32_bf16 v[92:95], a[124:127], a[60:63], v[92:95]
buffer_load_dwordx4 v3, s[16:19], s28 offen offset:1024 sc1 lds
s_sub_u32 s28, s28, 4096
v_mfma_f32_16x16x32_bf16 v[84:87], a[124:127], a[52:55], v[84:87]
v_mfma_f32_16x16x32_bf16 v[84:87], a[120:123], a[48:51], v[84:87]
s_add_u32 m0, s27, 24576
v_mfma_f32_16x16x32_bf16 v[76:79], a[120:123], a[40:43], v[76:79]
buffer_load_dwordx4 v3, s[16:19], s28 offen offset:0 sc1 lds
v_mfma_f32_16x16x32_bf16 v[76:79], a[124:127], a[44:47], v[76:79]
v_mfma_f32_16x16x32_bf16 v[68:71], a[124:127], a[36:39], v[68:71]
v_mfma_f32_16x16x32_bf16 v[68:71], a[120:123], a[32:35], v[68:71]
buffer_load_dwordx4 v3, s[16:19], s28 offen offset:1024 sc1 lds
s_sub_u32 s28, s28, 8448
v_pk_fma_f32 v[192:193], v[64:65], s[4:5], v[40:41]
v_pk_fma_f32 v[194:195], v[66:67], s[4:5], v[40:41]
s_nop 3
v_pk_fma_f32 v[198:199], v[70:71], s[4:5], v[40:41]
v_exp_f32_e64 v192, v192 clamp
v_exp_f32_e64 v193, v193 clamp
v_max_f32 v64, s32, v64
v_max_f32 v65, s32, v65
v_exp_f32_e64 v194, v194 clamp
v_exp_f32_e64 v195, v195 clamp
v_pk_fma_f32 v[204:205], v[76:77], s[4:5], v[40:41]
v_max_f32 v66, s32, v66
v_max_f32 v67, s32, v67
v_exp_f32_e64 v198, v198 clamp
v_exp_f32_e64 v199, v199 clamp
v_pk_fma_f32 v[216:217], v[88:89], s[4:5], v[40:41]
v_max_f32 v70, s32, v70
v_max_f32 v71, s32, v71
v_pk_add_f32 v[64:65], v[64:65], v[192:193]
v_exp_f32_e64 v204, v204 clamp
v_exp_f32_e64 v205, v205 clamp
v_pk_add_f32 v[66:67], v[66:67], v[194:195]
v_max_f32 v76, s32, v76
v_max_f32 v77, s32, v77
v_exp_f32_e64 v216, v216 clamp
v_exp_f32_e64 v217, v217 clamp
v_pk_add_f32 v[70:71], v[70:71], v[198:199]
v_cvt_pk_bf16_f32 v64, v64, v65
v_max_f32 v88, s32, v88
v_max_f32 v89, s32, v89
v_cvt_pk_bf16_f32 v65, v66, v67
v_pk_add_f32 v[76:77], v[76:77], v[204:205]
v_cvt_pk_bf16_f32 v67, v70, v71
v_pk_add_f32 v[88:89], v[88:89], v[216:217]
v_pk_mul_f32 v[184:185], v[184:185], s[6:7]
v_pk_mul_f32 v[186:187], v[186:187], s[6:7]
v_pk_mul_f32 v[188:189], v[188:189], s[6:7]
v_pk_mul_f32 v[190:191], v[190:191], s[6:7]
v_cvt_pk_bf16_f32 v70, v76, v77
v_cvt_pk_bf16_f32 v76, v88, v89
v_cvt_pk_bf16_f32 v28, v184, v185
v_cvt_pk_bf16_f32 v29, v186, v187
v_cvt_pk_bf16_f32 v30, v188, v189
s_add_u32 m0, s27, 20480
v_cvt_pk_bf16_f32 v31, v190, v191
buffer_load_dwordx4 v3, s[16:19], s28 offen offset:0 sc1 lds
v_pk_fma_f32 v[206:207], v[78:79], s[4:5], v[40:41]
v_pk_fma_f32 v[220:221], v[92:93], s[4:5], v[40:41]
v_exp_f32_e64 v206, v206 clamp
v_exp_f32_e64 v207, v207 clamp
v_max_f32 v78, s32, v78
v_max_f32 v79, s32, v79
v_exp_f32_e64 v220, v220 clamp
v_exp_f32_e64 v221, v221 clamp
v_max_f32 v92, s32, v92
v_max_f32 v93, s32, v93
v_pk_add_f32 v[78:79], v[78:79], v[206:207]
buffer_load_dword v57, v6, s[16:19], s37 offen sc1
v_pk_add_f32 v[92:93], v[92:93], v[220:221]
v_cvt_pk_bf16_f32 v71, v78, v79
v_cvt_pk_bf16_f32 v78, v92, v93
v_pk_fma_f32 v[222:223], v[94:95], s[4:5], v[40:41]
v_pk_fma_f32 v[218:219], v[90:91], s[4:5], v[40:41]
buffer_load_dwordx4 v3, s[16:19], s28 offen offset:1024 sc1 lds
ds_read_b64_tr_b16 a[192:193], v58 offset:0
ds_read_b64_tr_b16 a[194:195], v58 offset:2048
ds_read_b64_tr_b16 a[196:197], v59 offset:0
ds_read_b64_tr_b16 a[198:199], v59 offset:2048
s_sub_u32 s28, s28, 4096
ds_read_b64_tr_b16 a[200:201], v58 offset:512
ds_read_b64_tr_b16 a[202:203], v58 offset:2560
ds_read_b64_tr_b16 a[204:205], v59 offset:512
ds_read_b64_tr_b16 a[206:207], v59 offset:2560
v_exp_f32_e64 v222, v222 clamp
v_exp_f32_e64 v223, v223 clamp
v_max_f32 v94, s32, v94
v_max_f32 v95, s32, v95
s_add_u32 m0, s27, 16384
v_exp_f32_e64 v218, v218 clamp
buffer_load_dwordx4 v3, s[16:19], s28 offen offset:0 sc1 lds
v_exp_f32_e64 v219, v219 clamp
v_pk_add_f32 v[94:95], v[94:95], v[222:223]
v_max_f32 v90, s32, v90
v_max_f32 v91, s32, v91
v_cvt_pk_bf16_f32 v79, v94, v95
v_pk_add_f32 v[90:91], v[90:91], v[218:219]
v_pk_fma_f32 v[196:197], v[68:69], s[4:5], v[40:41]
v_cvt_pk_bf16_f32 v77, v90, v91
v_lshrrev_b32 v90, 4, v2
v_pk_fma_f32 v[200:201], v[72:73], s[4:5], v[40:41]
v_lshlrev_b32 v90, 4, v90
v_exp_f32_e64 v196, v196 clamp
v_exp_f32_e64 v197, v197 clamp
buffer_load_dwordx4 v3, s[16:19], s28 offen offset:1024 sc1 lds
s_waitcnt vmcnt(11)
v_pk_fma_f32 v[208:209], v[80:81], s[4:5], v[40:41]
v_pk_fma_f32 v[210:211], v[82:83], s[4:5], v[40:41]
v_max_f32 v68, s32, v68
v_max_f32 v69, s32, v69
v_exp_f32_e64 v200, v200 clamp
v_exp_f32_e64 v201, v201 clamp
v_max_f32 v72, s32, v72
v_max_f32 v73, s32, v73
v_exp_f32_e64 v208, v208 clamp
v_exp_f32_e64 v209, v209 clamp
s_add_u32 m0, s27, 12288
v_exp_f32_e64 v210, v210 clamp
buffer_load_dwordx4 v3, s[16:19], s39 offen offset:0 sc1 lds
ds_read_b64_tr_b16 a[208:209], v58 offset:16384
ds_read_b64_tr_b16 a[210:211], v58 offset:18432
ds_read_b64_tr_b16 a[212:213], v59 offset:16384
ds_read_b64_tr_b16 a[214:215], v59 offset:18432
ds_read_b64_tr_b16 a[216:217], v58 offset:16896
ds_read_b64_tr_b16 a[218:219], v58 offset:18944
ds_read_b64_tr_b16 a[220:221], v59 offset:16896
ds_read_b64_tr_b16 a[222:223], v59 offset:18944
v_exp_f32_e64 v211, v211 clamp
v_pk_add_f32 v[68:69], v[68:69], v[196:197]
v_max_f32 v80, s32, v80
v_max_f32 v81, s32, v81
v_max_f32 v82, s32, v82
v_max_f32 v83, s32, v83
buffer_load_dwordx4 v3, s[16:19], s39 offen offset:1024 sc1 lds
s_sub_u32 s39, s39, 4096
v_pk_add_f32 v[72:73], v[72:73], v[200:201]
v_cvt_pk_bf16_f32 v66, v68, v69
v_pk_add_f32 v[80:81], v[80:81], v[208:209]
v_pk_add_f32 v[82:83], v[82:83], v[210:211]
v_cvt_pk_bf16_f32 v68, v72, v73
v_cvt_pk_bf16_f32 v72, v80, v81
v_cvt_pk_bf16_f32 v73, v82, v83
v_pk_fma_f32 v[202:203], v[74:75], s[4:5], v[40:41]
v_pk_fma_f32 v[212:213], v[84:85], s[4:5], v[40:41]
v_pk_fma_f32 v[214:215], v[86:87], s[4:5], v[40:41]
v_exp_f32_e64 v202, v202 clamp
v_exp_f32_e64 v203, v203 clamp
s_add_u32 m0, s71, 147456
v_max_f32 v74, s32, v74
buffer_load_dwordx4 v61, s[44:47], s31 offen offset:1024  lds
ds_read_b128 v[208:211], v4 offset:38912
v_max_f32 v75, s32, v75
v_exp_f32_e64 v212, v212 clamp
v_exp_f32_e64 v213, v213 clamp
v_exp_f32_e64 v214, v214 clamp
v_exp_f32_e64 v215, v215 clamp
v_max_f32 v84, s32, v84
v_max_f32 v85, s32, v85
v_max_f32 v86, s32, v86
s_or_b32 s34, s35, 2
s_waitcnt vmcnt(6)
v_cmp_gt_u32 vcc, s34, v57
s_cbranch_vccnz P4_spin
P4_ok:
s_add_u32 m0, s27, 8192
s_nop 0
buffer_load_dwordx4 v3, s[16:19], s39 offen offset:0 sc1 lds
v_max_f32 v87, s32, v87
v_pk_add_f32 v[74:75], v[74:75], v[202:203]
v_pk_add_f32 v[84:85], v[84:85], v[212:213]
v_pk_add_f32 v[86:87], v[86:87], v[214:215]
v_cvt_pk_bf16_f32 v69, v74, v75
v_cvt_pk_bf16_f32 v74, v84, v85
v_cvt_pk_bf16_f32 v75, v86, v87
v_pk_mul_f32 v[160:161], v[160:161], s[6:7]
v_pk_mul_f32 v[162:163], v[162:163], s[6:7]
v_pk_mul_f32 v[164:165], v[164:165], s[6:7]
v_pk_mul_f32 v[166:167], v[166:167], s[6:7]
v_cvt_pk_bf16_f32 v16, v160, v161
v_cvt_pk_bf16_f32 v17, v162, v163
v_cvt_pk_bf16_f32 v18, v164, v165
v_cvt_pk_bf16_f32 v19, v166, v167
buffer_load_dwordx4 v[240:243], v10, s[16:19], s8 offen sc1
ds_read_b128 v[160:163], v4 offset:36864
ds_read_b128 v[164:167], v4 offset:37888
ds_read_b128 v[212:215], v4 offset:39936
s_add_u32 s8, s64, 108544
v_pk_mul_f32 v[176:177], v[176:177], s[6:7]
v_pk_mul_f32 v[178:179], v[178:179], s[6:7]
v_cvt_pk_bf16_f32 v24, v176, v177
v_cvt_pk_bf16_f32 v25, v178, v179
v_pk_mul_f32 v[180:181], v[180:181], s[6:7]
v_pk_mul_f32 v[182:183], v[182:183], s[6:7]
v_cvt_pk_bf16_f32 v26, v180, v181
v_cvt_pk_bf16_f32 v27, v182, v183
ds_read_b128 v[176:179], v4 offset:32768
buffer_load_dwordx4 v[244:247], v10, s[16:19], s8 offen sc1
ds_read_b128 v[180:183], v4 offset:33792
s_add_u32 s8, s64, 208896
v_permlane16_swap_b32 v24, v28
v_permlane16_swap_b32 v25, v29
v_permlane16_swap_b32 v26, v30
v_permlane16_swap_b32 v27, v31
v_pk_mul_f32 v[168:169], v[168:169], s[6:7]
v_pk_mul_f32 v[170:171], v[170:171], s[6:7]
v_pk_mul_f32 v[172:173], v[172:173], s[6:7]
v_pk_mul_f32 v[174:175], v[174:175], s[6:7]
v_cvt_pk_bf16_f32 v20, v168, v169
v_cvt_pk_bf16_f32 v21, v170, v171
v_cvt_pk_bf16_f32 v22, v172, v173
v_cvt_pk_bf16_f32 v23, v174, v175
s_waitcnt lgkmcnt(2)
v_mfma_f32_32x32x16_bf16 v[128:143], v[160:163], v[24:27], 0
buffer_load_dwordx4 v[248:251], v10, s[16:19], s8 offen sc1
s_add_u32 s8, s64, 309248
v_permlane16_swap_b32 v16, v20
v_permlane16_swap_b32 v17, v21
v_permlane16_swap_b32 v18, v22
v_mfma_f32_32x32x16_bf16 v[128:143], v[164:167], v[28:31], v[128:143]
v_permlane16_swap_b32 v19, v23
buffer_load_dwordx4 v[252:255], v10, s[16:19], s8 offen sc1
s_add_u32 s8, s3, 24960
s_waitcnt lgkmcnt(0)
v_mfma_f32_32x32x16_bf16 v[144:159], v[176:179], v[24:27], 0
s_nop 6
v_exp_f32 v128, v128
v_exp_f32 v129, v129
v_exp_f32 v130, v130
v_mfma_f32_32x32x16_bf16 v[144:159], v[180:183], v[28:31], v[144:159]
s_cmp_eq_u32 s61, 0
s_cbranch_scc1 Z_red
Z_ret:
s_add_u32 m0, s71, 147456
s_nop 0
buffer_load_dwordx4 v62, s[44:47], s31 offen offset:2048  lds
v_exp_f32 v131, v131
v_exp_f32 v132, v132
v_exp_f32 v133, v133
s_waitcnt vmcnt(9)
s_barrier
v_exp_f32 v134, v134
v_exp_f32 v135, v135
s_add_u32 m0, s27, 8192
v_exp_f32 v136, v136
buffer_load_dwordx4 v3, s[16:19], s39 offen offset:1024 sc1 lds
ds_read_b128 v[168:171], v4 offset:28672
ds_read_b128 v[172:175], v4 offset:29696
ds_read_b128 v[160:163], v4 offset:24576
ds_read_b128 v[164:167], v4 offset:25600
s_sub_u32 s39, s39, 8448
ds_read_b128 v[216:219], v4 offset:30720
ds_read_b128 v[220:223], v4 offset:31744
v_exp_f32 v137, v137
v_exp_f32 v138, v138
v_exp_f32 v139, v139
v_exp_f32 v140, v140
s_add_u32 m0, s71, 147456
v_exp_f32 v141, v141
buffer_load_dwordx4 v63, s[44:47], s31 offen offset:3072  lds
s_xor_b32 s31, s20, 655360
v_exp_f32 v142, v142
v_exp_f32 v143, v143
v_cvt_pk_bf16_f32 v192, v128, v129
v_cvt_pk_bf16_f32 v193, v130, v131
v_cvt_pk_bf16_f32 v194, v132, v133
v_cvt_pk_bf16_f32 v195, v134, v135
v_cvt_pk_bf16_f32 v196, v136, v137
v_cvt_pk_bf16_f32 v197, v138, v139
v_cvt_pk_bf16_f32 v198, v140, v141
s_waitcnt vmcnt(4)
v_add_f32 v240, v240, v248
v_add_f32 v241, v241, v249
v_add_f32 v242, v242, v250
s_add_u32 m0, s27, 4096
v_add_f32 v243, v243, v251
buffer_load_dwordx4 v3, s[16:19], s39 offen offset:0 sc1 lds
v_cvt_pk_bf16_f32 v199, v142, v143
v_and_b32 v192, v32, v192
v_and_b32 v193, v33, v193
s_waitcnt vmcnt(4)
v_add_f32 v244, v244, v252
v_add_f32 v245, v245, v253
v_add_f32 v246, v246, v254
v_add_f32 v247, v247, v255
v_add_f32 v240, v240, v244
v_add_f32 v241, v241, v245
v_add_f32 v242, v242, v246
v_add_f32 v243, v243, v247
v_permlane32_swap_b32 v240, v241
v_and_b32 v194, v34, v194
v_permlane32_swap_b32 v242, v243
v_add_f32 v240, v240, v241
s_add_u32 m0, s71, 131072
v_add_f32 v242, v242, v243
buffer_load_dwordx4 v60, s[44:47], s31 offen offset:0  lds
s_nop 0
v_permlane16_swap_b32 v240, v242
v_and_b32 v195, v35, v195
v_add_f32 v240, v240, v242
v_and_b32 v196, v36, v196
v_and_b32 v197, v37, v197
v_add_f32_dpp v240, v240, v240 row_ror:8 row_mask:0xf bank_mask:0xf
v_and_b32 v198, v38, v198
v_cvt_pk_bf16_f32 v88, v240, v240
v_and_b32 v199, v39, v199
v_mfma_f32_32x32x16_bf16 v[128:143], v[176:179], v[16:19], 0
s_add_u32 m0, s27, 4096
buffer_store_short v88, v8, s[16:19], s10 offen offset:128
ds_read_b128 v[176:179], v4 offset:20480
buffer_load_dwordx4 v3, s[16:19], s39 offen offset:1024 sc1 lds
s_sub_u32 s39, s39, 4096
v_exp_f32 v144, v144
v_exp_f32 v145, v145
v_exp_f32 v146, v146
v_mfma_f32_32x32x16_bf16 v[128:143], v[180:183], v[20:23], v[128:143]
s_add_u32 m0, s71, 131072
ds_read_b128 v[180:183], v4 offset:21504
v_exp_f32 v147, v147
v_exp_f32 v148, v148
v_exp_f32 v149, v149
v_mfma_f32_32x32x16_bf16 v[112:127], v[208:211], v[192:195], 0
buffer_load_dwordx4 v61, s[44:47], s31 offen offset:1024  lds
ds_read_b128 v[208:211], v4 offset:26624
v_exp_f32 v150, v150
v_exp_f32 v151, v151
v_exp_f32 v152, v152
s_add_u32 m0, s27, 0
v_mfma_f32_16x16x32_bf16 v[44:47], v[12:15], v[192:195], 0
buffer_load_dwordx4 v3, s[16:19], s39 offen offset:0 sc1 lds
v_exp_f32 v153, v153
v_mfma_f32_32x32x16_bf16 v[112:127], v[212:215], v[196:199], v[112:127]
s_add_u32 m0, s71, 131072
ds_read_b128 v[212:215], v4 offset:27648
v_exp_f32 v154, v154
v_exp_f32 v155, v155
v_exp_f32 v156, v156
v_mfma_f32_16x16x32_bf16 v[44:47], v[12:15], v[196:199], v[44:47]
buffer_load_dwordx4 v62, s[44:47], s31 offen offset:2048  lds
v_exp_f32 v157, v157
v_exp_f32 v158, v158
v_exp_f32 v159, v159
v_cvt_pk_bf16_f32 v200, v144, v145
v_cvt_pk_bf16_f32 v201, v146, v147
v_cvt_pk_bf16_f32 v202, v148, v149
v_cvt_pk_bf16_f32 v203, v150, v151
v_cvt_pk_bf16_f32 v204, v152, v153
v_mov_b32 v1, 3
s_cmp_lg_u32 s35, 0
s_waitcnt vmcnt(4)
s_cbranch_scc1 S5_far
buffer_store_dword v1, v9, s[16:19], s60 offen
S5_done:
s_add_u32 m0, s27, 0
s_nop 0
buffer_load_dwordx4 v3, s[16:19], s39 offen offset:1024 sc1 lds
v_cvt_pk_bf16_f32 v205, v154, v155
v_cvt_pk_bf16_f32 v206, v156, v157
v_cvt_pk_bf16_f32 v207, v158, v159
v_exp_f32 v128, v128
v_exp_f32 v129, v129
v_exp_f32 v130, v130
s_add_u32 m0, s71, 131072
v_mfma_f32_32x32x16_bf16 v[112:127], v[224:227], v[200:203], v[112:127]
buffer_load_dwordx4 v63, s[44:47], s31 offen offset:3072  lds
s_xor_b32 s31, s20, 786432
v_exp_f32 v131, v131
v_exp_f32 v132, v132
v_exp_f32 v133, v133
v_mfma_f32_16x16x32_bf16 v[44:47], v[12:15], v[200:203], v[44:47]
v_exp_f32 v134, v134
v_mfma_f32_32x32x16_bf16 v[112:127], v[228:231], v[204:207], v[112:127]
buffer_load_dwordx2 v[92:93], v55, s[16:19], s100 offen offset:0 sc1
v_exp_f32 v135, v135
v_exp_f32 v136, v136
v_exp_f32 v137, v137
v_mfma_f32_16x16x32_bf16 v[44:47], v[12:15], v[204:207], v[44:47]
buffer_load_dwordx2 v[94:95], v55, s[16:19], s100 offen offset:256 sc1
v_exp_f32 v138, v138
v_exp_f32 v139, v139
v_exp_f32 v140, v140
v_exp_f32 v141, v141
v_exp_f32 v142, v142
v_exp_f32 v143, v143
v_cvt_pk_bf16_f32 v192, v128, v129
v_cvt_pk_bf16_f32 v193, v130, v131
v_cvt_pk_bf16_f32 v194, v132, v133
v_cvt_pk_bf16_f32 v195, v134, v135
v_cvt_pk_bf16_f32 v196, v136, v137
v_cvt_pk_bf16_f32 v197, v138, v139
v_cvt_pk_bf16_f32 v198, v140, v141
v_cvt_pk_bf16_f32 v199, v142, v143
s_add_u32 m0, s71, 98304
s_waitcnt lgkmcnt(0)
v_mfma_f32_32x32x16_bf16 v[144:159], v[168:171], v[24:27], 0
buffer_load_dwordx4 v60, s[44:47], s31 offen offset:0  lds
v_and_b32 v192, v32, v192
v_and_b32 v193, v33, v193
v_and_b32 v194, v34, v194
v_and_b32 v195, v35, v195
v_and_b32 v196, v36, v196
v_and_b32 v197, v37, v197
v_mfma_f32_32x32x16_bf16 v[144:159], v[172:175], v[28:31], v[144:159]
v_and_b32 v198, v38, v198
v_and_b32 v199, v39, v199
buffer_load_dwordx4 v61, s[44:47], s31 offen offset:1024  lds
ds_read_b64_tr_b16 a[224:225], v58 offset:49152
ds_read_b64_tr_b16 a[226:227], v58 offset:51200
ds_read_b64_tr_b16 a[228:229], v59 offset:49152
ds_read_b64_tr_b16 a[230:231], v59 offset:51200
ds_read_b64_tr_b16 a[232:233], v58 offset:49664
ds_read_b64_tr_b16 a[234:235], v58 offset:51712
ds_read_b64_tr_b16 a[236:237], v59 offset:49664
ds_read_b64_tr_b16 a[238:239], v59 offset:51712
v_mfma_f32_32x32x16_bf16 v[128:143], v[168:171], v[16:19], 0
ds_read_b128 v[168:171], v4 offset:16384
v_exp_f32 v144, v144
v_exp_f32 v145, v145
v_exp_f32 v146, v146
v_mfma_f32_32x32x16_bf16 v[128:143], v[172:175], v[20:23], v[128:143]
ds_read_b128 v[172:175], v4 offset:17408
buffer_load_dwordx4 v62, s[44:47], s31 offen offset:2048  lds
v_exp_f32 v147, v147
v_exp_f32 v148, v148
v_exp_f32 v149, v149
v_mfma_f32_32x32x16_bf16 v[96:111], v[224:227], v[192:195], 0
ds_read_b128 v[224:227], v4 offset:22528
v_exp_f32 v150, v150
v_exp_f32 v151, v151
v_exp_f32 v152, v152
v_mfma_f32_16x16x32_bf16 v[40:43], v[12:15], v[192:195], 0
buffer_load_dwordx4 v63, s[44:47], s31 offen offset:3072  lds
s_xor_b32 s31, s20, 917504
v_exp_f32 v153, v153
v_mfma_f32_32x32x16_bf16 v[96:111], v[228:231], v[196:199], v[96:111]
s_add_u32 m0, s71, 114688
ds_read_b128 v[228:231], v4 offset:23552
v_exp_f32 v154, v154
v_exp_f32 v155, v155
v_exp_f32 v156, v156
v_mfma_f32_16x16x32_bf16 v[40:43], v[12:15], v[196:199], v[40:43]
buffer_load_dwordx4 v60, s[44:47], s31 offen offset:0  lds
v_exp_f32 v157, v157
v_exp_f32 v158, v158
v_exp_f32 v159, v159
v_cvt_pk_bf16_f32 v200, v144, v145
v_cvt_pk_bf16_f32 v201, v146, v147
v_cvt_pk_bf16_f32 v202, v148, v149
v_cvt_pk_bf16_f32 v203, v150, v151
v_cvt_pk_bf16_f32 v204, v152, v153
v_cvt_pk_bf16_f32 v205, v154, v155
s_waitcnt vmcnt(8)
s_barrier
v_cvt_pk_bf16_f32 v206, v156, v157
v_cvt_pk_bf16_f32 v207, v158, v159
buffer_load_dword v91, v6, s[16:19], s37 offen sc1
v_and_b32 v12, s12, v12
v_and_b32 v13, s12, v13
v_and_b32 v14, s12, v14
v_and_b32 v15, s12, v15
v_mfma_f32_32x32x16_bf16 v[144:159], v[160:163], v[24:27], 0
buffer_load_dwordx4 v61, s[44:47], s31 offen offset:1024  lds
v_exp_f32 v128, v128
v_exp_f32 v129, v129
v_exp_f32 v130, v130
v_mfma_f32_32x32x16_bf16 v[144:159], v[164:167], v[28:31], v[144:159]
v_exp_f32 v131, v131
v_exp_f32 v132, v132
v_exp_f32 v133, v133
v_mfma_f32_32x32x16_bf16 v[112:127], v[216:219], v[200:203], v[112:127]
buffer_load_dwordx4 v62, s[44:47], s31 offen offset:2048  lds
v_exp_f32 v134, v134
v_exp_f32 v135, v135
v_exp_f32 v136, v136
v_mfma_f32_16x16x32_bf16 v[44:47], v[12:15], v[200:203], v[44:47]
v_exp_f32 v137, v137
v_mfma_f32_32x32x16_bf16 v[112:127], v[220:223], v[204:207], v[112:127]
v_exp_f32 v138, v138
v_exp_f32 v139, v139
v_exp_f32 v140, v140
v_mfma_f32_16x16x32_bf16 v[44:47], v[12:15], v[204:207], v[44:47]
buffer_load_dwordx4 v63, s[44:47], s31 offen offset:3072  lds
s_xor_b32 s31, s20, 1048576
v_exp_f32 v141, v141
v_exp_f32 v142, v142
v_exp_f32 v143, v143
v_cvt_pk_bf16_f32 v192, v128, v129
v_cvt_pk_bf16_f32 v193, v130, v131
v_cvt_pk_bf16_f32 v194, v132, v133
v_cvt_pk_bf16_f32 v195, v134, v135
v_cvt_pk_bf16_f32 v196, v136, v137
v_cvt_pk_bf16_f32 v197, v138, v139
v_cvt_pk_bf16_f32 v198, v140, v141
v_cvt_pk_bf16_f32 v199, v142, v143
v_mfma_f32_32x32x16_bf16 v[128:143], v[160:163], v[16:19], 0
s_add_u32 m0, s71, 147456
ds_read_b128 v[160:163], v4 offset:12288
s_waitcnt lgkmcnt(1)
buffer_load_dwordx4 v60, s[44:47], s31 offen offset:0  lds
s_waitcnt vmcnt(12)
v_exp_f32 v144, v144
v_exp_f32 v145, v145
v_exp_f32 v146, v146
v_mfma_f32_32x32x16_bf16 v[128:143], v[164:167], v[20:23], v[128:143]
ds_read_b128 v[164:167], v4 offset:13312
ds_read_b64_tr_b16 a[240:241], v58 offset:32768
ds_read_b64_tr_b16 a[242:243], v58 offset:34816
ds_read_b64_tr_b16 a[244:245], v59 offset:32768
ds_read_b64_tr_b16 a[246:247], v59 offset:34816
buffer_load_dwordx4 v61, s[44:47], s31 offen offset:1024  lds
ds_read_b64_tr_b16 a[248:249], v58 offset:33280
ds_read_b64_tr_b16 a[250:251], v58 offset:35328
ds_read_b64_tr_b16 a[252:253], v59 offset:33280
ds_read_b64_tr_b16 a[254:255], v59 offset:35328
v_exp_f32 v147, v147
v_exp_f32 v148, v148
v_exp_f32 v149, v149
v_mfma_f32_32x32x16_bf16 v[96:111], v[216:219], v[192:195], v[96:111]
s_or_b32 s34, s35, 3
s_waitcnt vmcnt(5)
v_cmp_gt_u32 vcc, s34, v91
s_cbranch_vccnz P6_spin
P6_ok:
v_exp_f32 v150, v150
buffer_load_dwordx4 v[48:51], v90, s[16:19], s8 offen sc1
v_and_b32 v93, v93, v95
v_cmp_ne_u32 vcc, 1, v93
s_cbranch_vccnz G_spin
G_ok:
v_mov_b32 v52, v92
s_add_u32 s8, s3, 12416
v_mov_b32 v53, v92
v_mov_b32 v54, v94
v_mov_b32 v55, v94
v_permlane16_swap_b32 v52, v53
v_exp_f32 v151, v151
buffer_load_dwordx4 v[80:83], v11, s[16:19], s8 offen sc1
ds_read_b128 v[216:219], v4 offset:18432
s_add_u32 s8, s3, 213120
v_permlane16_swap_b32 v54, v55
v_exp_f32 v152, v152
v_mfma_f32_16x16x32_bf16 v[40:43], v[12:15], v[192:195], v[40:43]
v_exp_f32 v153, v153
v_mfma_f32_32x32x16_bf16 v[96:111], v[220:223], v[196:199], v[96:111]
buffer_load_dwordx4 v[84:87], v11, s[16:19], s8 offen sc1
ds_read_b128 v[220:223], v4 offset:19456
v_exp_f32 v154, v154
v_exp_f32 v155, v155
v_exp_f32 v156, v156
v_mfma_f32_16x16x32_bf16 v[40:43], v[12:15], v[196:199], v[40:43]
buffer_load_dwordx4 v62, s[44:47], s31 offen offset:2048  lds
v_exp_f32 v157, v157
v_exp_f32 v158, v158
v_exp_f32 v159, v159
v_cvt_pk_bf16_f32 v200, v144, v145
v_cvt_pk_bf16_f32 v201, v146, v147
v_cvt_pk_bf16_f32 v202, v148, v149
v_cvt_pk_bf16_f32 v203, v150, v151
v_cvt_pk_bf16_f32 v204, v152, v153
v_cvt_pk_bf16_f32 v205, v154, v155
v_cvt_pk_bf16_f32 v206, v156, v157
v_cvt_pk_bf16_f32 v207, v158, v159
v_mfma_f32_32x32x16_bf16 v[144:159], v[176:179], v[24:27], 0
buffer_load_dwordx4 v63, s[44:47], s31 offen offset:3072  lds
s_xor_b32 s31, s20, 1179648
v_exp_f32 v128, v128
v_exp_f32 v129, v129
v_exp_f32 v130, v130
v_mfma_f32_32x32x16_bf16 v[144:159], v[180:183], v[28:31], v[144:159]
s_add_u32 m0, s71, 131072
ds_read_b64_tr_b16 a[0:1], v58 offset:0
ds_read_b64_tr_b16 a[2:3], v58 offset:2048
ds_read_b64_tr_b16 a[4:5], v59 offset:0
ds_read_b64_tr_b16 a[6:7], v59 offset:2048
ds_read_b64_tr_b16 a[8:9], v58 offset:512
s_waitcnt lgkmcnt(5)
buffer_load_dwordx4 v60, s[44:47], s31 offen offset:0  lds
ds_read_b64_tr_b16 a[10:11], v58 offset:2560
ds_read_b64_tr_b16 a[12:13], v59 offset:512
ds_read_b64_tr_b16 a[14:15], v59 offset:2560
v_exp_f32 v131, v131
v_exp_f32 v132, v132
v_exp_f32 v133, v133
v_mfma_f32_32x32x16_bf16 v[112:127], v[208:211], v[200:203], v[112:127]
v_exp_f32 v134, v134
v_exp_f32 v135, v135
v_exp_f32 v136, v136
v_mfma_f32_16x16x32_bf16 v[44:47], v[12:15], v[200:203], v[44:47]
buffer_load_dwordx4 v61, s[44:47], s31 offen offset:1024  lds
v_exp_f32 v137, v137
v_mfma_f32_32x32x16_bf16 v[112:127], v[212:215], v[204:207], v[112:127]
v_exp_f32 v138, v138
v_exp_f32 v139, v139
v_exp_f32 v140, v140
v_mfma_f32_16x16x32_bf16 v[44:47], v[12:15], v[204:207], v[44:47]
v_exp_f32 v141, v141
s_waitcnt vmcnt(6)
v_mfma_f32_16x16x32_bf16 v[248:251], v[48:51], v[64:67], 0
buffer_load_dwordx4 v62, s[44:47], s31 offen offset:2048  lds
v_mfma_f32_16x16x32_bf16 v[252:255], v[48:51], v[68:71], 0
v_exp_f32 v142, v142
v_exp_f32 v143, v143
s_nop 3
v_add_f32 v248, s32, v248
v_cvt_pk_bf16_f32 v192, v128, v129
v_rcp_f32 v248, v248
v_add_f32 v252, s32, v252
v_mul_f32 v52, v248, v52
v_rcp_f32 v252, v252
v_mfma_f32_16x16x32_bf16 v[248:251], v[48:51], v[72:75], 0
buffer_load_dwordx4 v63, s[44:47], s31 offen offset:3072  lds
s_xor_b32 s31, s20, 1310720
v_mul_f32 v53, v252, v53
v_mfma_f32_16x16x32_bf16 v[252:255], v[48:51], v[76:79], 0
v_cvt_pk_bf16_f32 v193, v130, v131
v_cvt_pk_bf16_f32 v194, v132, v133
s_waitcnt vmcnt(7)
v_mfma_f32_16x16x32_bf16 v[240:243], v[80:83], v[64:67], 0
v_add_f32 v248, s32, v248
v_cvt_pk_bf16_f32 v195, v134, v135
s_waitcnt vmcnt(6)
v_mfma_f32_16x16x32_bf16 v[244:247], v[84:87], v[64:67], 0
s_add_u32 m0, s71, 98304
ds_read_b64_tr_b16 a[16:17], v58 offset:16384
ds_read_b64_tr_b16 a[18:19], v58 offset:18432
s_waitcnt lgkmcnt(2)
buffer_load_dwordx4 v60, s[44:47], s31 offen offset:0  lds
ds_read_b64_tr_b16 a[20:21], v59 offset:16384
ds_read_b64_tr_b16 a[22:23], v59 offset:18432
ds_read_b64_tr_b16 a[24:25], v58 offset:16896
ds_read_b64_tr_b16 a[26:27], v58 offset:18944
ds_read_b64_tr_b16 a[28:29], v59 offset:16896
ds_read_b64_tr_b16 a[30:31], v59 offset:18944
v_add_f32 v252, s32, v252
v_rcp_f32 v248, v248
v_rcp_f32 v252, v252
v_mul_f32 v54, v248, v54
v_mul_f32 v55, v252, v55
v_mfma_f32_16x16x32_bf16 v[248:251], v[80:83], v[68:71], 0
buffer_load_dwordx4 v61, s[44:47], s31 offen offset:1024  lds
v_mfma_f32_16x16x32_bf16 v[252:255], v[84:87], v[68:71], 0
v_mul_f32 v240, v52, v240
v_mul_f32 v241, v52, v241
v_mul_f32 v242, v52, v242
v_mul_f32 v243, v52, v243
v_mul_f32 v244, v52, v244
v_mul_f32 v245, v52, v245
v_mul_f32 v246, v52, v246
v_mul_f32 v247, v52, v247
v_cvt_pk_bf16_f32 v64, v240, v241
v_cvt_pk_bf16_f32 v65, v242, v243
v_cvt_pk_bf16_f32 v66, v244, v245
v_cvt_pk_bf16_f32 v67, v246, v247
v_mfma_f32_16x16x32_bf16 v[240:243], v[80:83], v[72:75], 0
buffer_store_dwordx4 v[64:67], v3, s[16:19], s62 offen offset:0 sc1
v_mfma_f32_16x16x32_bf16 v[244:247], v[84:87], v[72:75], 0
v_mul_f32 v248, v53, v248
v_mul_f32 v249, v53, v249
v_mul_f32 v250, v53, v250
v_mul_f32 v251, v53, v251
v_mul_f32 v252, v53, v252
v_mul_f32 v253, v53, v253
v_mul_f32 v254, v53, v254
v_mul_f32 v255, v53, v255
v_cvt_pk_bf16_f32 v68, v248, v249
v_cvt_pk_bf16_f32 v69, v250, v251
v_cvt_pk_bf16_f32 v70, v252, v253
v_cvt_pk_bf16_f32 v71, v254, v255
v_mfma_f32_16x16x32_bf16 v[248:251], v[80:83], v[76:79], 0
buffer_store_dwordx4 v[68:71], v3, s[16:19], s62 offen offset:1024 sc1
v_mfma_f32_16x16x32_bf16 v[252:255], v[84:87], v[76:79], 0
v_mul_f32 v240, v54, v240
v_mul_f32 v241, v54, v241
v_mul_f32 v242, v54, v242
v_mul_f32 v243, v54, v243
v_mul_f32 v244, v54, v244
v_mul_f32 v245, v54, v245
v_mul_f32 v246, v54, v246
v_mul_f32 v247, v54, v247
v_cvt_pk_bf16_f32 v72, v240, v241
v_cvt_pk_bf16_f32 v73, v242, v243
v_cvt_pk_bf16_f32 v74, v244, v245
v_cvt_pk_bf16_f32 v75, v246, v247
v_mul_f32 v248, v55, v248
v_mul_f32 v249, v55, v249
v_mul_f32 v250, v55, v250
v_mul_f32 v251, v55, v251
v_mul_f32 v252, v55, v252
buffer_store_dwordx4 v[72:75], v3, s[16:19], s62 offen offset:2048 sc1
v_mul_f32 v253, v55, v253
v_mul_f32 v254, v55, v254
v_mul_f32 v255, v55, v255
v_cvt_pk_bf16_f32 v76, v248, v249
v_cvt_pk_bf16_f32 v77, v250, v251
v_cvt_pk_bf16_f32 v78, v252, v253
v_cvt_pk_bf16_f32 v79, v254, v255
v_cvt_pk_bf16_f32 v196, v136, v137
v_cvt_pk_bf16_f32 v197, v138, v139
v_cvt_pk_bf16_f32 v198, v140, v141
v_cvt_pk_bf16_f32 v199, v142, v143
v_mfma_f32_32x32x16_bf16 v[128:143], v[176:179], v[16:19], 0
buffer_store_dwordx4 v[76:79], v3, s[16:19], s62 offen offset:3072 sc1
ds_read_b128 v[176:179], v4 offset:8192
v_exp_f32 v144, v144
v_exp_f32 v145, v145
v_exp_f32 v146, v146
v_mfma_f32_32x32x16_bf16 v[128:143], v[180:183], v[20:23], v[128:143]
ds_read_b128 v[180:183], v4 offset:9216
buffer_load_dwordx4 v62, s[44:47], s31 offen offset:2048  lds
s_waitcnt vmcnt(11)
v_exp_f32 v147, v147
v_exp_f32 v148, v148
v_exp_f32 v149, v149
v_mfma_f32_32x32x16_bf16 v[96:111], v[208:211], v[192:195], v[96:111]
ds_read_b128 v[208:211], v4 offset:14336
ds_read_b64_tr_b16 a[32:33], v58 offset:49152
ds_read_b64_tr_b16 a[34:35], v58 offset:51200
ds_read_b64_tr_b16 a[36:37], v59 offset:49152
ds_read_b64_tr_b16 a[38:39], v59 offset:51200
buffer_load_dwordx4 v63, s[44:47], s31 offen offset:3072  lds
ds_read_b64_tr_b16 a[40:41], v58 offset:49664
ds_read_b64_tr_b16 a[42:43], v58 offset:51712
ds_read_b64_tr_b16 a[44:45], v59 offset:49664
ds_read_b64_tr_b16 a[46:47], v59 offset:51712
s_xor_b32 s31, s20, 1441792
v_exp_f32 v150, v150
v_exp_f32 v151, v151
v_exp_f32 v152, v152
v_mfma_f32_16x16x32_bf16 v[40:43], v[12:15], v[192:195], v[40:43]
v_exp_f32 v153, v153
v_mfma_f32_32x32x16_bf16 v[96:111], v[212:215], v[196:199], v[96:111]
s_add_u32 m0, s71, 114688
ds_read_b128 v[212:215], v4 offset:15360
s_waitcnt lgkmcnt(10)
buffer_load_dwordx4 v60, s[44:47], s31 offen offset:0  lds
v_exp_f32 v154, v154
v_exp_f32 v155, v155
v_exp_f32 v156, v156
v_mfma_f32_16x16x32_bf16 v[40:43], v[12:15], v[196:199], v[40:43]
v_exp_f32 v157, v157
v_exp_f32 v158, v158
v_exp_f32 v159, v159
v_cvt_pk_bf16_f32 v200, v144, v145
v_cvt_pk_bf16_f32 v201, v146, v147
v_cvt_pk_bf16_f32 v202, v148, v149
v_cvt_pk_bf16_f32 v203, v150, v151
v_cvt_pk_bf16_f32 v204, v152, v153
v_cvt_pk_bf16_f32 v205, v154, v155
v_cvt_pk_bf16_f32 v206, v156, v157
v_cvt_pk_bf16_f32 v207, v158, v159
v_and_b32 v12, s13, v12
v_and_b32 v13, s13, v13
v_and_b32 v14, s13, v14
v_and_b32 v15, s13, v15
v_mfma_f32_32x32x16_bf16 v[144:159], v[168:171], v[24:27], 0
buffer_load_dwordx4 v61, s[44:47], s31 offen offset:1024  lds
v_exp_f32 v128, v128
v_exp_f32 v129, v129
v_exp_f32 v130, v130
v_mfma_f32_32x32x16_bf16 v[144:159], v[172:175], v[28:31], v[144:159]
s_waitcnt vmcnt(10)
v_exp_f32 v131, v131
v_exp_f32 v132, v132
v_exp_f32 v133, v133
v_mfma_f32_32x32x16_bf16 v[112:127], v[224:227], v[200:203], v[112:127]
buffer_load_dwordx4 v62, s[44:47], s31 offen offset:2048  lds
ds_read_b64_tr_b16 a[48:49], v58 offset:32768
ds_read_b64_tr_b16 a[50:51], v58 offset:34816
ds_read_b64_tr_b16 a[52:53], v59 offset:32768
ds_read_b64_tr_b16 a[54:55], v59 offset:34816
ds_read_b64_tr_b16 a[56:57], v58 offset:33280
ds_read_b64_tr_b16 a[58:59], v58 offset:35328
ds_read_b64_tr_b16 a[60:61], v59 offset:33280
ds_read_b64_tr_b16 a[62:63], v59 offset:35328
v_exp_f32 v134, v134
v_exp_f32 v135, v135
v_exp_f32 v136, v136
v_mfma_f32_16x16x32_bf16 v[44:47], v[12:15], v[200:203], v[44:47]
buffer_load_dwordx4 v63, s[44:47], s31 offen offset:3072  lds
s_xor_b32 s31, s20, 1572864
v_exp_f32 v137, v137
v_mfma_f32_32x32x16_bf16 v[112:127], v[228:231], v[204:207], v[112:127]
v_exp_f32 v138, v138
v_exp_f32 v139, v139
v_exp_f32 v140, v140
v_mfma_f32_16x16x32_bf16 v[44:47], v[12:15], v[204:207], v[44:47]
v_exp_f32 v141, v141
v_exp_f32 v142, v142
v_exp_f32 v143, v143
v_cvt_pk_bf16_f32 v192, v128, v129
v_cvt_pk_bf16_f32 v193, v130, v131
v_cvt_pk_bf16_f32 v194, v132, v133
v_cvt_pk_bf16_f32 v195, v134, v135
v_cvt_pk_bf16_f32 v196, v136, v137
v_cvt_pk_bf16_f32 v197, v138, v139
v_cvt_pk_bf16_f32 v198, v140, v141
v_cvt_pk_bf16_f32 v199, v142, v143
v_mfma_f32_32x32x16_bf16 v[128:143], v[168:171], v[16:19], 0
s_add_u32 m0, s71, 147456
ds_read_b128 v[168:171], v4 offset:4096
s_waitcnt lgkmcnt(1)
buffer_load_dwordx4 v60, s[44:47], s31 offen offset:0  lds
v_exp_f32 v144, v144
v_exp_f32 v145, v145
v_exp_f32 v146, v146
v_mfma_f32_32x32x16_bf16 v[128:143], v[172:175], v[20:23], v[128:143]
ds_read_b128 v[172:175], v4 offset:5120
v_exp_f32 v147, v147
v_exp_f32 v148, v148
v_exp_f32 v149, v149
v_mfma_f32_32x32x16_bf16 v[96:111], v[224:227], v[192:195], v[96:111]
ds_read_b128 v[224:227], v4 offset:10240
buffer_load_dwordx4 v61, s[44:47], s31 offen offset:1024  lds
v_exp_f32 v150, v150
v_exp_f32 v151, v151
v_exp_f32 v152, v152
v_mfma_f32_16x16x32_bf16 v[40:43], v[12:15], v[192:195], v[40:43]
v_exp_f32 v153, v153
v_mfma_f32_32x32x16_bf16 v[96:111], v[228:231], v[196:199], v[96:111]
ds_read_b128 v[228:231], v4 offset:11264
buffer_load_dwordx4 v62, s[44:47], s31 offen offset:2048  lds
v_exp_f32 v154, v154
v_exp_f32 v155, v155
v_exp_f32 v156, v156
v_mfma_f32_16x16x32_bf16 v[40:43], v[12:15], v[196:199], v[40:43]
v_exp_f32 v157, v157
v_exp_f32 v158, v158
v_exp_f32 v159, v159
v_cvt_pk_bf16_f32 v200, v144, v145
v_cvt_pk_bf16_f32 v201, v146, v147
v_cvt_pk_bf16_f32 v202, v148, v149
v_cvt_pk_bf16_f32 v203, v150, v151
v_cvt_pk_bf16_f32 v204, v152, v153
v_cvt_pk_bf16_f32 v205, v154, v155
v_cvt_pk_bf16_f32 v206, v156, v157
v_cvt_pk_bf16_f32 v207, v158, v159
v_mfma_f32_32x32x16_bf16 v[144:159], v[160:163], v[24:27], 0
buffer_load_dwordx4 v63, s[44:47], s31 offen offset:3072  lds
s_xor_b32 s31, s20, 1703936
v_exp_f32 v128, v128
v_exp_f32 v129, v129
v_exp_f32 v130, v130
v_mfma_f32_32x32x16_bf16 v[144:159], v[164:167], v[28:31], v[144:159]
s_add_u32 m0, s71, 131072
v_exp_f32 v131, v131
v_exp_f32 v132, v132
v_exp_f32 v133, v133
v_mfma_f32_32x32x16_bf16 v[112:127], v[216:219], v[200:203], v[112:127]
buffer_load_dwordx4 v60, s[44:47], s31 offen offset:0  lds
s_waitcnt vmcnt(9)
v_exp_f32 v134, v134
v_exp_f32 v135, v135
v_exp_f32 v136, v136
v_mfma_f32_16x16x32_bf16 v[44:47], v[12:15], v[200:203], v[44:47]
ds_read_b64_tr_b16 a[64:65], v58 offset:0
ds_read_b64_tr_b16 a[66:67], v58 offset:2048
ds_read_b64_tr_b16 a[68:69], v59 offset:0
ds_read_b64_tr_b16 a[70:71], v59 offset:2048
ds_read_b64_tr_b16 a[72:73], v58 offset:512
buffer_load_dwordx4 v61, s[44:47], s31 offen offset:1024  lds
ds_read_b64_tr_b16 a[74:75], v58 offset:2560
ds_read_b64_tr_b16 a[76:77], v59 offset:512
ds_read_b64_tr_b16 a[78:79], v59 offset:2560
v_exp_f32 v137, v137
v_mfma_f32_32x32x16_bf16 v[112:127], v[220:223], v[204:207], v[112:127]
v_exp_f32 v138, v138
v_exp_f32 v139, v139
v_exp_f32 v140, v140
v_mfma_f32_16x16x32_bf16 v[44:47], v[12:15], v[204:207], v[44:47]
buffer_load_dwordx4 v62, s[44:47], s31 offen offset:2048  lds
v_exp_f32 v141, v141
v_exp_f32 v142, v142
v_exp_f32 v143, v143
v_cvt_pk_bf16_f32 v192, v128, v129
v_cvt_pk_bf16_f32 v193, v130, v131
v_cvt_pk_bf16_f32 v194, v132, v133
v_cvt_pk_bf16_f32 v195, v134, v135
v_cvt_pk_bf16_f32 v196, v136, v137
v_cvt_pk_bf16_f32 v197, v138, v139
v_cvt_pk_bf16_f32 v198, v140, v141
v_cvt_pk_bf16_f32 v199, v142, v143
v_mfma_f32_32x32x16_bf16 v[128:143], v[160:163], v[16:19], 0
ds_read_b128 v[160:163], v4 offset:0
buffer_load_dwordx4 v63, s[44:47], s31 offen offset:3072  lds
s_xor_b32 s31, s20, 1835008
v_exp_f32 v144, v144
v_exp_f32 v145, v145
v_exp_f32 v146, v146
v_mfma_f32_32x32x16_bf16 v[128:143], v[164:167], v[20:23], v[128:143]
ds_read_b128 v[164:167], v4 offset:1024
v_mov_b32 v1, 1
buffer_store_dword v1, v9, s[16:19], s33 offen offset:512 sc1
v_exp_f32 v147, v147
v_exp_f32 v148, v148
v_exp_f32 v149, v149
v_mfma_f32_32x32x16_bf16 v[96:111], v[216:219], v[192:195], v[96:111]
s_add_u32 m0, s71, 98304
ds_read_b128 v[216:219], v4 offset:6144
s_waitcnt lgkmcnt(3)
buffer_load_dwordx4 v60, s[44:47], s31 offen offset:0  lds
v_exp_f32 v150, v150
v_exp_f32 v151, v151
v_exp_f32 v152, v152
v_mfma_f32_16x16x32_bf16 v[40:43], v[12:15], v[192:195], v[40:43]
s_waitcnt vmcnt(10)
v_exp_f32 v153, v153
v_mfma_f32_32x32x16_bf16 v[96:111], v[220:223], v[196:199], v[96:111]
ds_read_b128 v[220:223], v4 offset:7168
buffer_load_dwordx4 v61, s[44:47], s31 offen offset:1024  lds
ds_read_b64_tr_b16 a[80:81], v58 offset:16384
ds_read_b64_tr_b16 a[82:83], v58 offset:18432
ds_read_b64_tr_b16 a[84:85], v59 offset:16384
ds_read_b64_tr_b16 a[86:87], v59 offset:18432
ds_read_b64_tr_b16 a[88:89], v58 offset:16896
ds_read_b64_tr_b16 a[90:91], v58 offset:18944
ds_read_b64_tr_b16 a[92:93], v59 offset:16896
ds_read_b64_tr_b16 a[94:95], v59 offset:18944
v_exp_f32 v154, v154
v_exp_f32 v155, v155
v_exp_f32 v156, v156
v_mfma_f32_16x16x32_bf16 v[40:43], v[12:15], v[196:199], v[40:43]
buffer_load_dwordx4 v62, s[44:47], s31 offen offset:2048  lds
v_exp_f32 v157, v157
v_exp_f32 v158, v158
v_exp_f32 v159, v159
v_cvt_pk_bf16_f32 v200, v144, v145
v_cvt_pk_bf16_f32 v201, v146, v147
v_cvt_pk_bf16_f32 v202, v148, v149
v_cvt_pk_bf16_f32 v203, v150, v151
v_cvt_pk_bf16_f32 v204, v152, v153
v_cvt_pk_bf16_f32 v205, v154, v155
v_cvt_pk_bf16_f32 v206, v156, v157
v_cvt_pk_bf16_f32 v207, v158, v159
v_and_b32 v12, s14, v12
v_and_b32 v13, s14, v13
v_and_b32 v14, s14, v14
v_and_b32 v15, s14, v15
v_mfma_f32_32x32x16_bf16 v[144:159], v[176:179], v[24:27], 0
buffer_load_dwordx4 v63, s[44:47], s31 offen offset:3072  lds
s_xor_b32 s31, s20, 1966080
v_exp_f32 v128, v128
v_exp_f32 v129, v129
v_exp_f32 v130, v130
v_mfma_f32_32x32x16_bf16 v[144:159], v[180:183], v[28:31], v[144:159]
s_add_u32 m0, s71, 114688
v_exp_f32 v131, v131
v_exp_f32 v132, v132
v_exp_f32 v133, v133
v_mfma_f32_32x32x16_bf16 v[112:127], v[208:211], v[200:203], v[112:127]
s_waitcnt lgkmcnt(0)
buffer_load_dwordx4 v60, s[44:47], s31 offen offset:0  lds
v_exp_f32 v134, v134
v_exp_f32 v135, v135
v_exp_f32 v136, v136
v_mfma_f32_16x16x32_bf16 v[44:47], v[12:15], v[200:203], v[44:47]
v_exp_f32 v137, v137
v_mfma_f32_32x32x16_bf16 v[112:127], v[212:215], v[204:207], v[112:127]
v_exp_f32 v138, v138
v_exp_f32 v139, v139
v_exp_f32 v140, v140
v_mfma_f32_16x16x32_bf16 v[44:47], v[12:15], v[204:207], v[44:47]
buffer_load_dwordx4 v61, s[44:47], s31 offen offset:1024  lds
s_waitcnt vmcnt(11)
v_exp_f32 v141, v141
v_exp_f32 v142, v142
v_exp_f32 v143, v143
v_cvt_pk_bf16_f32 v192, v128, v129
v_cvt_pk_bf16_f32 v193, v130, v131
v_cvt_pk_bf16_f32 v194, v132, v133
v_cvt_pk_bf16_f32 v195, v134, v135
v_cvt_pk_bf16_f32 v196, v136, v137
v_cvt_pk_bf16_f32 v197, v138, v139
v_cvt_pk_bf16_f32 v198, v140, v141
v_cvt_pk_bf16_f32 v199, v142, v143
v_mfma_f32_32x32x16_bf16 v[128:143], v[176:179], v[16:19], 0
buffer_load_dwordx4 v62, s[44:47], s31 offen offset:2048  lds
ds_read_b64_tr_b16 a[96:97], v58 offset:49152
ds_read_b64_tr_b16 a[98:99], v58 offset:51200
ds_read_b64_tr_b16 a[100:101], v59 offset:49152
ds_read_b64_tr_b16 a[102:103], v59 offset:51200
ds_read_b64_tr_b16 a[104:105], v58 offset:49664
ds_read_b64_tr_b16 a[106:107], v58 offset:51712
ds_read_b64_tr_b16 a[108:109], v59 offset:49664
ds_read_b64_tr_b16 a[110:111], v59 offset:51712
v_exp_f32 v144, v144
v_exp_f32 v145, v145
v_exp_f32 v146, v146
v_mfma_f32_32x32x16_bf16 v[128:143], v[180:183], v[20:23], v[128:143]
buffer_load_dwordx4 v63, s[44:47], s31 offen offset:3072  lds
s_xor_b32 s31, s20, 0
v_exp_f32 v147, v147
v_exp_f32 v148, v148
v_exp_f32 v149, v149
v_mfma_f32_32x32x16_bf16 v[96:111], v[208:211], v[192:195], v[96:111]
ds_read_b128 v[208:211], v4 offset:2048
v_exp_f32 v150, v150
v_exp_f32 v151, v151
v_exp_f32 v152, v152
v_mfma_f32_16x16x32_bf16 v[40:43], v[12:15], v[192:195], v[40:43]
v_exp_f32 v153, v153
v_mfma_f32_32x32x16_bf16 v[96:111], v[212:215], v[196:199], v[96:111]
s_add_u32 m0, s71, 147456
ds_read_b128 v[212:215], v4 offset:3072
s_waitcnt lgkmcnt(2)
buffer_load_dwordx4 v60, s[48:51], s31 offen offset:0  lds
v_exp_f32 v154, v154
v_exp_f32 v155, v155
v_exp_f32 v156, v156
v_mfma_f32_16x16x32_bf16 v[40:43], v[12:15], v[196:199], v[40:43]
v_exp_f32 v157, v157
v_exp_f32 v158, v158
v_exp_f32 v159, v159
v_cvt_pk_bf16_f32 v200, v144, v145
v_cvt_pk_bf16_f32 v201, v146, v147
v_cvt_pk_bf16_f32 v202, v148, v149
v_cvt_pk_bf16_f32 v203, v150, v151
v_cvt_pk_bf16_f32 v204, v152, v153
v_cvt_pk_bf16_f32 v205, v154, v155
v_cvt_pk_bf16_f32 v206, v156, v157
v_cvt_pk_bf16_f32 v207, v158, v159
v_mfma_f32_32x32x16_bf16 v[144:159], v[168:171], v[24:27], 0
buffer_load_dwordx4 v61, s[48:51], s31 offen offset:1024  lds
s_waitcnt vmcnt(11)
v_exp_f32 v128, v128
v_exp_f32 v129, v129
v_exp_f32 v130, v130
v_mfma_f32_32x32x16_bf16 v[144:159], v[172:175], v[28:31], v[144:159]
s_waitcnt lgkmcnt(0)
s_barrier
v_exp_f32 v131, v131
v_exp_f32 v132, v132
v_exp_f32 v133, v133
v_mfma_f32_32x32x16_bf16 v[112:127], v[224:227], v[200:203], v[112:127]
buffer_load_dwordx4 v62, s[48:51], s31 offen offset:2048  lds
ds_read_b64_tr_b16 a[112:113], v58 offset:32768
ds_read_b64_tr_b16 a[114:115], v58 offset:34816
ds_read_b64_tr_b16 a[116:117], v59 offset:32768
ds_read_b64_tr_b16 a[118:119], v59 offset:34816
ds_read_b64_tr_b16 a[120:121], v58 offset:33280
ds_read_b64_tr_b16 a[122:123], v58 offset:35328
ds_read_b64_tr_b16 a[124:125], v59 offset:33280
ds_read_b64_tr_b16 a[126:127], v59 offset:35328
v_exp_f32 v134, v134
v_exp_f32 v135, v135
v_exp_f32 v136, v136
v_mfma_f32_16x16x32_bf16 v[44:47], v[12:15], v[200:203], v[44:47]
buffer_load_dwordx4 v63, s[48:51], s31 offen offset:3072  lds
s_xor_b32 s31, s20, 131072
v_exp_f32 v137, v137
v_mfma_f32_32x32x16_bf16 v[112:127], v[228:231], v[204:207], v[112:127]
v_exp_f32 v138, v138
v_exp_f32 v139, v139
v_exp_f32 v140, v140
v_mfma_f32_16x16x32_bf16 v[44:47], v[12:15], v[204:207], v[44:47]
s_add_u32 m0, s71, 131072
v_exp_f32 v141, v141
v_exp_f32 v142, v142
v_exp_f32 v143, v143
v_cvt_pk_bf16_f32 v192, v128, v129
v_cvt_pk_bf16_f32 v193, v130, v131
v_cvt_pk_bf16_f32 v194, v132, v133
v_cvt_pk_bf16_f32 v195, v134, v135
v_cvt_pk_bf16_f32 v196, v136, v137
v_cvt_pk_bf16_f32 v197, v138, v139
v_cvt_pk_bf16_f32 v198, v140, v141
v_cvt_pk_bf16_f32 v199, v142, v143
v_mfma_f32_32x32x16_bf16 v[128:143], v[168:171], v[16:19], 0
s_waitcnt lgkmcnt(0)
buffer_load_dwordx4 v60, s[48:51], s31 offen offset:0  lds
s_waitcnt vmcnt(9)
v_exp_f32 v144, v144
v_exp_f32 v145, v145
v_exp_f32 v146, v146
v_mfma_f32_32x32x16_bf16 v[128:143], v[172:175], v[20:23], v[128:143]
ds_read_b64_tr_b16 a[128:129], v58 offset:0
ds_read_b64_tr_b16 a[130:131], v58 offset:2048
ds_read_b64_tr_b16 a[132:133], v59 offset:0
ds_read_b64_tr_b16 a[134:135], v59 offset:2048
ds_read_b64_tr_b16 a[136:137], v58 offset:512
buffer_load_dwordx4 v61, s[48:51], s31 offen offset:1024  lds
ds_read_b64_tr_b16 a[138:139], v58 offset:2560
ds_read_b64_tr_b16 a[140:141], v59 offset:512
ds_read_b64_tr_b16 a[142:143], v59 offset:2560
v_exp_f32 v147, v147
v_exp_f32 v148, v148
v_exp_f32 v149, v149
v_mfma_f32_32x32x16_bf16 v[96:111], v[224:227], v[192:195], v[96:111]
v_exp_f32 v150, v150
v_exp_f32 v151, v151
v_exp_f32 v152, v152
v_mfma_f32_16x16x32_bf16 v[40:43], v[12:15], v[192:195], v[40:43]
buffer_load_dwordx4 v62, s[48:51], s31 offen offset:2048  lds
v_exp_f32 v153, v153
v_mfma_f32_32x32x16_bf16 v[96:111], v[228:231], v[196:199], v[96:111]
v_exp_f32 v154, v154
v_exp_f32 v155, v155
v_exp_f32 v156, v156
v_mfma_f32_16x16x32_bf16 v[40:43], v[12:15], v[196:199], v[40:43]
v_exp_f32 v157, v157
v_exp_f32 v158, v158
v_exp_f32 v159, v159
v_cvt_pk_bf16_f32 v200, v144, v145
v_cvt_pk_bf16_f32 v201, v146, v147
v_cvt_pk_bf16_f32 v202, v148, v149
v_cvt_pk_bf16_f32 v203, v150, v151
v_cvt_pk_bf16_f32 v204, v152, v153
v_cvt_pk_bf16_f32 v205, v154, v155
v_cvt_pk_bf16_f32 v206, v156, v157
v_cvt_pk_bf16_f32 v207, v158, v159
v_bfi_b32 v200, v32, 0, v200
v_bfi_b32 v201, v33, 0, v201
v_bfi_b32 v202, v34, 0, v202
v_bfi_b32 v203, v35, 0, v203
v_bfi_b32 v204, v36, 0, v204
v_bfi_b32 v205, v37, 0, v205
v_bfi_b32 v206, v38, 0, v206
v_bfi_b32 v207, v39, 0, v207
v_and_b32 v12, s15, v12
v_and_b32 v13, s15, v13
v_and_b32 v14, s15, v14
v_and_b32 v15, s15, v15
v_mfma_f32_32x32x16_bf16 v[144:159], v[160:163], v[16:19], 0
buffer_load_dwordx4 v63, s[48:51], s31 offen offset:3072  lds
s_xor_b32 s31, s20, 262144
s_waitcnt vmcnt(8)
v_exp_f32 v128, v128
v_exp_f32 v129, v129
v_exp_f32 v130, v130
v_mfma_f32_32x32x16_bf16 v[144:159], v[164:167], v[20:23], v[144:159]
s_add_u32 m0, s71, 98304
ds_read_b64_tr_b16 a[144:145], v58 offset:16384
ds_read_b64_tr_b16 a[146:147], v58 offset:18432
ds_read_b64_tr_b16 a[148:149], v59 offset:16384
ds_read_b64_tr_b16 a[150:151], v59 offset:18432
ds_read_b64_tr_b16 a[152:153], v58 offset:16896
s_waitcnt lgkmcnt(5)
buffer_load_dwordx4 v60, s[48:51], s31 offen offset:0  lds
ds_read_b64_tr_b16 a[154:155], v58 offset:18944
ds_read_b64_tr_b16 a[156:157], v59 offset:16896
ds_read_b64_tr_b16 a[158:159], v59 offset:18944
v_exp_f32 v131, v131
v_exp_f32 v132, v132
v_exp_f32 v133, v133
v_mfma_f32_32x32x16_bf16 v[112:127], v[216:219], v[200:203], v[112:127]
v_exp_f32 v134, v134
v_exp_f32 v135, v135
v_exp_f32 v136, v136
v_mfma_f32_16x16x32_bf16 v[44:47], v[12:15], v[200:203], v[44:47]
buffer_load_dword v10, v7, s[16:19], s38 offen offset:512 sc1
v_exp_f32 v137, v137
v_mfma_f32_32x32x16_bf16 v[112:127], v[220:223], v[204:207], v[112:127]
buffer_load_dwordx4 v61, s[48:51], s31 offen offset:1024  lds
v_exp_f32 v138, v138
v_exp_f32 v139, v139
v_exp_f32 v140, v140
v_mfma_f32_16x16x32_bf16 v[44:47], v[12:15], v[204:207], v[44:47]
v_exp_f32 v141, v141
v_exp_f32 v142, v142
v_exp_f32 v143, v143
v_cvt_pk_bf16_f32 v192, v128, v129
v_cvt_pk_bf16_f32 v193, v130, v131
v_cvt_pk_bf16_f32 v194, v132, v133
v_cvt_pk_bf16_f32 v195, v134, v135
v_cvt_pk_bf16_f32 v196, v136, v137
v_cvt_pk_bf16_f32 v197, v138, v139
v_cvt_pk_bf16_f32 v198, v140, v141
v_cvt_pk_bf16_f32 v199, v142, v143
v_exp_f32 v144, v144
v_exp_f32 v145, v145
v_exp_f32 v146, v146
v_exp_f32 v147, v147
v_exp_f32 v148, v148
v_exp_f32 v149, v149
v_mfma_f32_32x32x16_bf16 v[96:111], v[216:219], v[192:195], v[96:111]
buffer_load_dwordx4 v62, s[48:51], s31 offen offset:2048  lds
v_exp_f32 v150, v150
v_exp_f32 v151, v151
v_exp_f32 v152, v152
v_mfma_f32_16x16x32_bf16 v[40:43], v[12:15], v[192:195], v[40:43]
v_exp_f32 v153, v153
v_mfma_f32_32x32x16_bf16 v[96:111], v[220:223], v[196:199], v[96:111]
v_exp_f32 v154, v154
v_exp_f32 v155, v155
v_exp_f32 v156, v156
v_mfma_f32_16x16x32_bf16 v[40:43], v[12:15], v[196:199], v[40:43]
buffer_load_dwordx4 v63, s[48:51], s31 offen offset:3072  lds
s_xor_b32 s31, s20, 393216
v_exp_f32 v157, v157
v_exp_f32 v158, v158
v_exp_f32 v159, v159
v_cvt_pk_bf16_f32 v200, v144, v145
v_cvt_pk_bf16_f32 v201, v146, v147
v_cvt_pk_bf16_f32 v202, v148, v149
v_cvt_pk_bf16_f32 v203, v150, v151
v_cvt_pk_bf16_f32 v204, v152, v153
v_cvt_pk_bf16_f32 v205, v154, v155
v_cvt_pk_bf16_f32 v206, v156, v157
v_cvt_pk_bf16_f32 v207, v158, v159
v_bfi_b32 v200, v32, 0, v200
v_bfi_b32 v201, v33, 0, v201
v_bfi_b32 v202, v34, 0, v202
v_bfi_b32 v203, v35, 0, v203
v_bfi_b32 v204, v36, 0, v204
v_bfi_b32 v205, v37, 0, v205
v_bfi_b32 v206, v38, 0, v206
v_bfi_b32 v207, v39, 0, v207
s_add_u32 m0, s71, 114688
v_mfma_f32_32x32x16_bf16 v[96:111], v[208:211], v[200:203], v[96:111]
s_waitcnt lgkmcnt(0)
buffer_load_dwordx4 v60, s[48:51], s31 offen offset:0  lds
v_sub_f32 v56, 1.0, v92
v_sub_f32 v57, 1.0, v94
v_mfma_f32_16x16x32_bf16 v[40:43], v[12:15], v[200:203], v[40:43]
v_mfma_f32_32x32x16_bf16 v[96:111], v[212:215], v[204:207], v[96:111]
buffer_load_dwordx4 v61, s[48:51], s31 offen offset:1024  lds
v_mfma_f32_16x16x32_bf16 v[40:43], v[12:15], v[204:207], v[40:43]
s_nop 7
v_subrev_u32 v232, 0x1f800000, v40
v_subrev_u32 v233, 0x1f800000, v44
v_max_u32 v232, v232, v233
v_cmp_le_u32 vcc, 2.0, v232
s_cbranch_vccnz SLOW
SLOW_ret:
v_rcp_f32 v40, v40
v_rcp_f32 v44, v44
v_mul_f32 v40, v40, v56
v_mul_f32 v44, v44, v57
v_mov_b32 v41, v40
v_mov_b32 v45, v44
v_pk_mul_f32 v[96:97], v[96:97], v[40:41]
v_pk_mul_f32 v[98:99], v[98:99], v[40:41]
v_pk_mul_f32 v[100:101], v[100:101], v[40:41]
v_pk_mul_f32 v[102:103], v[102:103], v[40:41]
v_cvt_pk_bf16_f32 v96, v96, v97
v_cvt_pk_bf16_f32 v97, v98, v99
v_cvt_pk_bf16_f32 v98, v100, v101
v_cvt_pk_bf16_f32 v99, v102, v103
v_pk_mul_f32 v[104:105], v[104:105], v[40:41]
v_pk_mul_f32 v[106:107], v[106:107], v[40:41]
v_pk_mul_f32 v[108:109], v[108:109], v[40:41]
v_pk_mul_f32 v[110:111], v[110:111], v[40:41]
v_cvt_pk_bf16_f32 v104, v104, v105
buffer_store_dwordx4 v[96:99], v5, s[16:19], s63 offen offset:0 sc1
s_mul_i32 s9, s29, 6144
v_cvt_pk_bf16_f32 v105, v106, v107
v_cvt_pk_bf16_f32 v106, v108, v109
v_cvt_pk_bf16_f32 v107, v110, v111
v_pk_mul_f32 v[112:113], v[112:113], v[44:45]
v_pk_mul_f32 v[114:115], v[114:115], v[44:45]
v_pk_mul_f32 v[116:117], v[116:117], v[44:45]
v_pk_mul_f32 v[118:119], v[118:119], v[44:45]
v_cvt_pk_bf16_f32 v112, v112, v113
v_cvt_pk_bf16_f32 v113, v114, v115
buffer_store_dwordx4 v[104:107], v5, s[16:19], s63 offen offset:256 sc1
v_cvt_pk_bf16_f32 v114, v116, v117
v_cvt_pk_bf16_f32 v115, v118, v119
v_pk_mul_f32 v[120:121], v[120:121], v[44:45]
v_pk_mul_f32 v[122:123], v[122:123], v[44:45]
v_pk_mul_f32 v[124:125], v[124:125], v[44:45]
v_pk_mul_f32 v[126:127], v[126:127], v[44:45]
v_cvt_pk_bf16_f32 v120, v120, v121
v_cvt_pk_bf16_f32 v121, v122, v123
v_cvt_pk_bf16_f32 v122, v124, v125
buffer_store_dwordx4 v[112:115], v5, s[16:19], s63 offen offset:2048 sc1
v_cvt_pk_bf16_f32 v123, v126, v127
v_add_u32 v12, s9, v3
v_xor_b32 v13, 2048, v12
v_add_u32 v14, 65536, v12
v_add_u32 v15, 65536, v13
buffer_store_dwordx4 v[120:123], v5, s[16:19], s63 offen offset:2304 sc1
buffer_load_dwordx4 v62, s[48:51], s31 offen offset:2048  lds
buffer_load_dwordx4 v63, s[48:51], s31 offen offset:3072  lds
s_waitcnt vmcnt(11)
v_cmp_gt_u32 vcc, 1, v10
s_cbranch_vccnz P7_spin
P7_ok:
s_add_u32 m0, s65, 0
s_nop 0
buffer_load_dwordx4 v3, s[16:19], s30 offen offset:0 sc1 lds
buffer_load_dwordx4 v3, s[16:19], s30 offen offset:1024 sc1 lds
s_add_u32 m0, s65, 8192
s_xor_b32 s30, s21, 8192
buffer_load_dwordx4 v3, s[16:19], s30 offen offset:0 sc1 lds
buffer_load_dwordx4 v3, s[16:19], s30 offen offset:1024 sc1 lds
s_add_u32 m0, s65, 16384
s_xor_b32 s30, s21, 16384
buffer_load_dwordx4 v3, s[16:19], s30 offen offset:0 sc1 lds
buffer_load_dwordx4 v3, s[16:19], s30 offen offset:1024 sc1 lds
s_add_u32 m0, s65, 24576
s_xor_b32 s30, s21, 24576
buffer_load_dwordx4 v3, s[16:19], s30 offen offset:0 sc1 lds
buffer_load_dwordx4 v3, s[16:19], s30 offen offset:1024 sc1 lds
s_xor_b32 s30, s21, 32768
s_waitcnt vmcnt(6)
s_waitcnt vmcnt(4)
s_barrier
ds_read_b128 v[192:195], v12 offset:0
ds_read_b128 v[196:199], v12 offset:8192
ds_read_b128 v[200:203], v12 offset:9216
ds_read_b128 v[204:207], v12 offset:1024
s_waitcnt lgkmcnt(3)
v_mfma_f32_16x16x32_bf16 v[128:131], a[160:163], v[192:195], 0
s_waitcnt lgkmcnt(2)
v_mfma_f32_16x16x32_bf16 v[128:131], a[176:179], v[196:199], v[128:131]
ds_read_b128 v[208:211], v13 offset:0
s_add_u32 m0, s65, 32768
s_waitcnt lgkmcnt(2)
v_mfma_f32_16x16x32_bf16 v[144:147], a[176:179], v[200:203], 0
buffer_load_dwordx4 v3, s[16:19], s30 offen offset:0 sc1 lds
s_waitcnt lgkmcnt(1)
v_mfma_f32_16x16x32_bf16 v[144:147], a[160:163], v[204:207], v[144:147]
ds_read_b128 v[212:215], v13 offset:8192
v_mfma_f32_16x16x32_bf16 v[148:151], a[164:167], v[204:207], 0
ds_read_b128 v[216:219], v13 offset:9216
v_mfma_f32_16x16x32_bf16 v[148:151], a[180:183], v[200:203], v[148:151]
buffer_load_dwordx4 v3, s[16:19], s30 offen offset:1024 sc1 lds
v_mfma_f32_16x16x32_bf16 v[132:135], a[180:183], v[196:199], 0
ds_read_b128 v[220:223], v13 offset:1024
s_xor_b32 s30, s21, 40960
v_mfma_f32_16x16x32_bf16 v[132:135], a[164:167], v[192:195], v[132:135]
v_mfma_f32_16x16x32_bf16 v[136:139], a[168:171], v[192:195], 0
v_mov_b32 v1, 1
buffer_store_dword v1, v9, s[16:19], s33 offen offset:1536 sc1
s_add_u32 m0, s65, 40960
v_mfma_f32_16x16x32_bf16 v[136:139], a[184:187], v[196:199], v[136:139]
buffer_load_dwordx4 v3, s[16:19], s30 offen offset:0 sc1 lds
v_mfma_f32_16x16x32_bf16 v[152:155], a[184:187], v[200:203], 0
v_mfma_f32_16x16x32_bf16 v[152:155], a[168:171], v[204:207], v[152:155]
v_mfma_f32_16x16x32_bf16 v[156:159], a[172:175], v[204:207], 0
v_mfma_f32_16x16x32_bf16 v[156:159], a[188:191], v[200:203], v[156:159]
buffer_load_dwordx4 v3, s[16:19], s30 offen offset:1024 sc1 lds
v_mfma_f32_16x16x32_bf16 v[140:143], a[188:191], v[196:199], 0
s_xor_b32 s30, s21, 49152
v_mfma_f32_16x16x32_bf16 v[140:143], a[172:175], v[192:195], v[140:143]
s_waitcnt lgkmcnt(1)
v_mfma_f32_16x16x32_bf16 v[160:163], a[160:163], v[208:211], 0
s_waitcnt vmcnt(5)
s_barrier
s_add_u32 m0, s65, 49152
v_mfma_f32_16x16x32_bf16 v[160:163], a[176:179], v[212:215], v[160:163]
buffer_load_dwordx4 v3, s[16:19], s30 offen offset:0 sc1 lds
v_mfma_f32_16x16x32_bf16 v[176:179], a[176:179], v[216:219], 0
ds_read_b128 v[192:195], v12 offset:16384
s_waitcnt lgkmcnt(1)
v_mfma_f32_16x16x32_bf16 v[176:179], a[160:163], v[220:223], v[176:179]
ds_read_b128 v[196:199], v12 offset:24576
v_mfma_f32_16x16x32_bf16 v[180:183], a[164:167], v[220:223], 0
ds_read_b128 v[200:203], v12 offset:25600
v_mfma_f32_16x16x32_bf16 v[180:183], a[180:183], v[216:219], v[180:183]
buffer_load_dwordx4 v3, s[16:19], s30 offen offset:1024 sc1 lds
v_mfma_f32_16x16x32_bf16 v[164:167], a[180:183], v[212:215], 0
ds_read_b128 v[204:207], v12 offset:17408
s_xor_b32 s30, s21, 57344
v_mfma_f32_16x16x32_bf16 v[164:167], a[164:167], v[208:211], v[164:167]
ds_read_b64_tr_b16 a[160:161], v58 offset:49152
s_add_u32 m0, s65, 57344
v_mfma_f32_16x16x32_bf16 v[168:171], a[168:171], v[208:211], 0
buffer_load_dwordx4 v3, s[16:19], s30 offen offset:0 sc1 lds
v_mfma_f32_16x16x32_bf16 v[168:171], a[184:187], v[212:215], v[168:171]
ds_read_b64_tr_b16 a[162:163], v58 offset:51200
v_mfma_f32_16x16x32_bf16 v[184:187], a[184:187], v[216:219], 0
ds_read_b64_tr_b16 a[164:165], v59 offset:49152
v_mfma_f32_16x16x32_bf16 v[184:187], a[168:171], v[220:223], v[184:187]
ds_read_b64_tr_b16 a[166:167], v59 offset:51200
v_mfma_f32_16x16x32_bf16 v[188:191], a[172:175], v[220:223], 0
buffer_load_dwordx4 v3, s[16:19], s30 offen offset:1024 sc1 lds
v_mfma_f32_16x16x32_bf16 v[188:191], a[188:191], v[216:219], v[188:191]
ds_read_b64_tr_b16 a[168:169], v58 offset:49664
s_xor_b32 s30, s21, 65536
v_mfma_f32_16x16x32_bf16 v[172:175], a[188:191], v[212:215], 0
ds_read_b64_tr_b16 a[170:171], v58 offset:51712
v_mfma_f32_16x16x32_bf16 v[172:175], a[172:175], v[208:211], v[172:175]
s_add_u32 m0, s65, 65536
s_waitcnt lgkmcnt(6)
v_mfma_f32_16x16x32_bf16 v[128:131], a[192:195], v[192:195], v[128:131]
buffer_load_dwordx4 v3, s[16:19], s30 offen offset:0 sc1 lds
v_mfma_f32_16x16x32_bf16 v[128:131], a[208:211], v[196:199], v[128:131]
ds_read_b128 v[208:211], v13 offset:16384
v_mfma_f32_16x16x32_bf16 v[144:147], a[208:211], v[200:203], v[144:147]
ds_read_b128 v[212:215], v13 offset:24576
v_mfma_f32_16x16x32_bf16 v[144:147], a[192:195], v[204:207], v[144:147]
ds_read_b128 v[216:219], v13 offset:25600
v_mfma_f32_16x16x32_bf16 v[148:151], a[196:199], v[204:207], v[148:151]
buffer_load_dwordx4 v3, s[16:19], s30 offen offset:1024 sc1 lds
v_mfma_f32_16x16x32_bf16 v[148:151], a[212:215], v[200:203], v[148:151]
ds_read_b128 v[220:223], v13 offset:17408
s_xor_b32 s30, s21, 73728
v_mfma_f32_16x16x32_bf16 v[132:135], a[212:215], v[196:199], v[132:135]
ds_read_b64_tr_b16 a[172:173], v59 offset:49664
v_mfma_f32_16x16x32_bf16 v[132:135], a[196:199], v[192:195], v[132:135]
ds_read_b64_tr_b16 a[174:175], v59 offset:51712
s_add_u32 m0, s65, 73728
v_mfma_f32_16x16x32_bf16 v[136:139], a[200:203], v[192:195], v[136:139]
buffer_load_dwordx4 v3, s[16:19], s30 offen offset:0 sc1 lds
v_mfma_f32_16x16x32_bf16 v[136:139], a[216:219], v[196:199], v[136:139]
ds_read_b64_tr_b16 a[176:177], v58 offset:32768
v_mfma_f32_16x16x32_bf16 v[152:155], a[216:219], v[200:203], v[152:155]
ds_read_b64_tr_b16 a[178:179], v58 offset:34816
v_mfma_f32_16x16x32_bf16 v[152:155], a[200:203], v[204:207], v[152:155]
buffer_load_dwordx4 v3, s[16:19], s30 offen offset:1024 sc1 lds
v_mfma_f32_16x16x32_bf16 v[156:159], a[204:207], v[204:207], v[156:159]
ds_read_b64_tr_b16 a[180:181], v59 offset:32768
s_xor_b32 s30, s21, 81920
v_mfma_f32_16x16x32_bf16 v[156:159], a[220:223], v[200:203], v[156:159]
ds_read_b64_tr_b16 a[182:183], v59 offset:34816
s_xor_b32 s31, s20, 524288
v_mfma_f32_16x16x32_bf16 v[140:143], a[220:223], v[196:199], v[140:143]
ds_read_b64_tr_b16 a[184:185], v58 offset:33280
s_waitcnt lgkmcnt(5)
s_add_u32 m0, s71, 147456
v_mfma_f32_16x16x32_bf16 v[140:143], a[204:207], v[192:195], v[140:143]
buffer_load_dwordx4 v60, s[48:51], s31 offen offset:0  lds
v_mfma_f32_16x16x32_bf16 v[160:163], a[192:195], v[208:211], v[160:163]
s_waitcnt vmcnt(9)
s_barrier
v_mfma_f32_16x16x32_bf16 v[160:163], a[208:211], v[212:215], v[160:163]
ds_read_b128 v[192:195], v12 offset:32768
v_mfma_f32_16x16x32_bf16 v[176:179], a[208:211], v[216:219], v[176:179]
ds_read_b128 v[196:199], v12 offset:40960
v_mfma_f32_16x16x32_bf16 v[176:179], a[192:195], v[220:223], v[176:179]
buffer_load_dwordx4 v61, s[48:51], s31 offen offset:1024  lds
v_mfma_f32_16x16x32_bf16 v[180:183], a[196:199], v[220:223], v[180:183]
ds_read_b128 v[200:203], v12 offset:41984
v_mfma_f32_16x16x32_bf16 v[180:183], a[212:215], v[216:219], v[180:183]
ds_read_b128 v[204:207], v12 offset:33792
v_mfma_f32_16x16x32_bf16 v[164:167], a[212:215], v[212:215], v[164:167]
ds_read_b64_tr_b16 a[186:187], v58 offset:35328
s_add_u32 m0, s71, 147456
v_mfma_f32_16x16x32_bf16 v[164:167], a[196:199], v[208:211], v[164:167]
buffer_load_dwordx4 v62, s[48:51], s31 offen offset:2048  lds
v_mfma_f32_16x16x32_bf16 v[168:171], a[200:203], v[208:211], v[168:171]
ds_read_b64_tr_b16 a[188:189], v59 offset:33280
v_mfma_f32_16x16x32_bf16 v[168:171], a[216:219], v[212:215], v[168:171]
ds_read_b64_tr_b16 a[190:191], v59 offset:35328
v_mfma_f32_16x16x32_bf16 v[184:187], a[216:219], v[216:219], v[184:187]
ds_read_b64_tr_b16 a[192:193], v58 offset:0
v_mfma_f32_16x16x32_bf16 v[184:187], a[200:203], v[220:223], v[184:187]
buffer_load_dwordx4 v63, s[48:51], s31 offen offset:3072  lds
v_mfma_f32_16x16x32_bf16 v[188:191], a[204:207], v[220:223], v[188:191]
ds_read_b64_tr_b16 a[194:195], v58 offset:2048
v_mfma_f32_16x16x32_bf16 v[188:191], a[220:223], v[216:219], v[188:191]
ds_read_b64_tr_b16 a[196:197], v59 offset:0
v_mfma_f32_16x16x32_bf16 v[172:175], a[220:223], v[212:215], v[172:175]
v_mfma_f32_16x16x32_bf16 v[172:175], a[204:207], v[208:211], v[172:175]
ds_read_b64_tr_b16 a[198:199], v59 offset:2048
s_waitcnt lgkmcnt(7)
v_mfma_f32_16x16x32_bf16 v[128:131], a[224:227], v[192:195], v[128:131]
ds_read_b64_tr_b16 a[200:201], v58 offset:512
v_mfma_f32_16x16x32_bf16 v[128:131], a[240:243], v[196:199], v[128:131]
ds_read_b128 v[208:211], v13 offset:32768
v_mfma_f32_16x16x32_bf16 v[144:147], a[240:243], v[200:203], v[144:147]
v_mfma_f32_16x16x32_bf16 v[144:147], a[224:227], v[204:207], v[144:147]
ds_read_b128 v[212:215], v13 offset:40960
v_mfma_f32_16x16x32_bf16 v[148:151], a[228:231], v[204:207], v[148:151]
ds_read_b128 v[216:219], v13 offset:41984
s_xor_b32 s31, s20, 655360
v_mfma_f32_16x16x32_bf16 v[148:151], a[244:247], v[200:203], v[148:151]
ds_read_b128 v[220:223], v13 offset:33792
s_waitcnt lgkmcnt(8)
s_add_u32 m0, s71, 131072
v_mfma_f32_16x16x32_bf16 v[132:135], a[244:247], v[196:199], v[132:135]
buffer_load_dwordx4 v60, s[48:51], s31 offen offset:0  lds
v_mfma_f32_16x16x32_bf16 v[132:135], a[228:231], v[192:195], v[132:135]
ds_read_b64_tr_b16 a[202:203], v58 offset:2560
v_mfma_f32_16x16x32_bf16 v[136:139], a[232:235], v[192:195], v[136:139]
ds_read_b64_tr_b16 a[204:205], v59 offset:512
v_mfma_f32_16x16x32_bf16 v[136:139], a[248:251], v[196:199], v[136:139]
ds_read_b64_tr_b16 a[206:207], v59 offset:2560
v_mfma_f32_16x16x32_bf16 v[152:155], a[248:251], v[200:203], v[152:155]
buffer_load_dwordx4 v61, s[48:51], s31 offen offset:1024  lds
v_mfma_f32_16x16x32_bf16 v[152:155], a[232:235], v[204:207], v[152:155]
ds_read_b64_tr_b16 a[208:209], v58 offset:16384
v_mfma_f32_16x16x32_bf16 v[156:159], a[236:239], v[204:207], v[156:159]
ds_read_b64_tr_b16 a[210:211], v58 offset:18432
v_mfma_f32_16x16x32_bf16 v[156:159], a[252:255], v[200:203], v[156:159]
ds_read_b64_tr_b16 a[212:213], v59 offset:16384
s_add_u32 m0, s65, 81920
v_mfma_f32_16x16x32_bf16 v[140:143], a[252:255], v[196:199], v[140:143]
buffer_load_dwordx4 v3, s[16:19], s30 offen offset:0 sc1 lds
v_mfma_f32_16x16x32_bf16 v[140:143], a[236:239], v[192:195], v[140:143]
ds_read_b64_tr_b16 a[214:215], v59 offset:18432
s_waitcnt lgkmcnt(7)
v_mfma_f32_16x16x32_bf16 v[160:163], a[224:227], v[208:211], v[160:163]
s_waitcnt vmcnt(11)
s_barrier
v_mfma_f32_16x16x32_bf16 v[160:163], a[240:243], v[212:215], v[160:163]
buffer_load_dwordx4 v3, s[16:19], s30 offen offset:1024 sc1 lds
v_mfma_f32_16x16x32_bf16 v[176:179], a[240:243], v[216:219], v[176:179]
ds_read_b128 v[192:195], v12 offset:49152
s_xor_b32 s30, s21, 90112
v_mfma_f32_16x16x32_bf16 v[176:179], a[224:227], v[220:223], v[176:179]
ds_read_b128 v[196:199], v12 offset:57344
v_mfma_f32_16x16x32_bf16 v[180:183], a[228:231], v[220:223], v[180:183]
ds_read_b128 v[200:203], v12 offset:58368
s_add_u32 m0, s65, 90112
v_mfma_f32_16x16x32_bf16 v[180:183], a[244:247], v[216:219], v[180:183]
buffer_load_dwordx4 v3, s[16:19], s30 offen offset:0 sc1 lds
v_mfma_f32_16x16x32_bf16 v[164:167], a[244:247], v[212:215], v[164:167]
ds_read_b128 v[204:207], v12 offset:50176
v_mfma_f32_16x16x32_bf16 v[164:167], a[228:231], v[208:211], v[164:167]
ds_read_b64_tr_b16 a[216:217], v58 offset:16896
v_mfma_f32_16x16x32_bf16 v[168:171], a[232:235], v[208:211], v[168:171]
ds_read_b64_tr_b16 a[218:219], v58 offset:18944
v_mfma_f32_16x16x32_bf16 v[168:171], a[248:251], v[212:215], v[168:171]
buffer_load_dwordx4 v3, s[16:19], s30 offen offset:1024 sc1 lds
v_mfma_f32_16x16x32_bf16 v[184:187], a[248:251], v[216:219], v[184:187]
ds_read_b64_tr_b16 a[220:221], v59 offset:16896
s_xor_b32 s30, s21, 98304
v_mfma_f32_16x16x32_bf16 v[184:187], a[232:235], v[220:223], v[184:187]
ds_read_b64_tr_b16 a[222:223], v59 offset:18944
v_mfma_f32_16x16x32_bf16 v[188:191], a[236:239], v[220:223], v[188:191]
s_add_u32 m0, s71, 131072
v_mfma_f32_16x16x32_bf16 v[188:191], a[252:255], v[216:219], v[188:191]
buffer_load_dwordx4 v62, s[48:51], s31 offen offset:2048  lds
v_mfma_f32_16x16x32_bf16 v[172:175], a[252:255], v[212:215], v[172:175]
v_mfma_f32_16x16x32_bf16 v[172:175], a[236:239], v[208:211], v[172:175]
s_waitcnt lgkmcnt(5)
v_mfma_f32_16x16x32_bf16 v[128:131], a[0:3], v[192:195], v[128:131]
v_mfma_f32_16x16x32_bf16 v[128:131], a[16:19], v[196:199], v[128:131]
buffer_load_dwordx4 v63, s[48:51], s31 offen offset:3072  lds
v_mfma_f32_16x16x32_bf16 v[144:147], a[16:19], v[200:203], v[144:147]
ds_read_b128 v[208:211], v13 offset:49152
s_xor_b32 s31, s20, 786432
s_waitcnt lgkmcnt(3)
v_mfma_f32_16x16x32_bf16 v[144:147], a[0:3], v[204:207], v[144:147]
ds_read_b128 v[212:215], v13 offset:57344
s_add_u32 m0, s71, 98304
v_mfma_f32_16x16x32_bf16 v[148:151], a[4:7], v[204:207], v[148:151]
buffer_load_dwordx4 v60, s[48:51], s31 offen offset:0  lds
v_mfma_f32_16x16x32_bf16 v[148:151], a[20:23], v[200:203], v[148:151]
ds_read_b128 v[216:219], v13 offset:58368
v_mfma_f32_16x16x32_bf16 v[132:135], a[20:23], v[196:199], v[132:135]
ds_read_b128 v[220:223], v13 offset:50176
v_mfma_f32_16x16x32_bf16 v[132:135], a[4:7], v[192:195], v[132:135]
s_waitcnt vmcnt(9)
ds_read_b64_tr_b16 a[224:225], v58 offset:49152
v_mfma_f32_16x16x32_bf16 v[136:139], a[8:11], v[192:195], v[136:139]
buffer_load_dwordx4 v61, s[48:51], s31 offen offset:1024  lds
v_mfma_f32_16x16x32_bf16 v[136:139], a[24:27], v[196:199], v[136:139]
buffer_load_dword v10, v7, s[16:19], s38 offen offset:1536 sc1
v_mfma_f32_16x16x32_bf16 v[152:155], a[24:27], v[200:203], v[152:155]
ds_read_b64_tr_b16 a[226:227], v58 offset:51200
v_mfma_f32_16x16x32_bf16 v[152:155], a[8:11], v[204:207], v[152:155]
ds_read_b64_tr_b16 a[228:229], v59 offset:49152
s_add_u32 m0, s65, 0
v_mfma_f32_16x16x32_bf16 v[156:159], a[12:15], v[204:207], v[156:159]
buffer_load_dwordx4 v3, s[16:19], s30 offen offset:0 sc1 lds
v_mfma_f32_16x16x32_bf16 v[156:159], a[28:31], v[200:203], v[156:159]
ds_read_b64_tr_b16 a[230:231], v59 offset:51200
v_mfma_f32_16x16x32_bf16 v[140:143], a[28:31], v[196:199], v[140:143]
ds_read_b64_tr_b16 a[232:233], v58 offset:49664
v_mfma_f32_16x16x32_bf16 v[140:143], a[12:15], v[192:195], v[140:143]
ds_read_b64_tr_b16 a[234:235], v58 offset:51712
s_waitcnt lgkmcnt(6)
v_mfma_f32_16x16x32_bf16 v[160:163], a[0:3], v[208:211], v[160:163]
s_barrier
v_mfma_f32_16x16x32_bf16 v[160:163], a[16:19], v[212:215], v[160:163]
buffer_load_dwordx4 v3, s[16:19], s30 offen offset:1024 sc1 lds
v_mfma_f32_16x16x32_bf16 v[176:179], a[16:19], v[216:219], v[176:179]
ds_read_b128 v[192:195], v14 offset:0
s_xor_b32 s30, s21, 106496
v_mfma_f32_16x16x32_bf16 v[176:179], a[0:3], v[220:223], v[176:179]
ds_read_b128 v[196:199], v14 offset:8192
s_add_u32 m0, s65, 8192
v_mfma_f32_16x16x32_bf16 v[180:183], a[4:7], v[220:223], v[180:183]
buffer_load_dwordx4 v3, s[16:19], s30 offen offset:0 sc1 lds
v_mfma_f32_16x16x32_bf16 v[180:183], a[20:23], v[216:219], v[180:183]
ds_read_b128 v[200:203], v14 offset:9216
v_mfma_f32_16x16x32_bf16 v[164:167], a[20:23], v[212:215], v[164:167]
ds_read_b128 v[204:207], v14 offset:1024
v_mfma_f32_16x16x32_bf16 v[164:167], a[4:7], v[208:211], v[164:167]
buffer_load_dwordx4 v3, s[16:19], s30 offen offset:1024 sc1 lds
v_mfma_f32_16x16x32_bf16 v[168:171], a[8:11], v[208:211], v[168:171]
ds_read_b64_tr_b16 a[236:237], v59 offset:49664
s_xor_b32 s30, s21, 114688
v_mfma_f32_16x16x32_bf16 v[168:171], a[24:27], v[212:215], v[168:171]
ds_read_b64_tr_b16 a[238:239], v59 offset:51712
v_mfma_f32_16x16x32_bf16 v[184:187], a[24:27], v[216:219], v[184:187]
s_add_u32 m0, s71, 98304
v_mfma_f32_16x16x32_bf16 v[184:187], a[8:11], v[220:223], v[184:187]
buffer_load_dwordx4 v62, s[48:51], s31 offen offset:2048  lds
v_mfma_f32_16x16x32_bf16 v[188:191], a[12:15], v[220:223], v[188:191]
v_mfma_f32_16x16x32_bf16 v[188:191], a[28:31], v[216:219], v[188:191]
v_mfma_f32_16x16x32_bf16 v[172:175], a[28:31], v[212:215], v[172:175]
v_mfma_f32_16x16x32_bf16 v[172:175], a[12:15], v[208:211], v[172:175]
buffer_load_dwordx4 v63, s[48:51], s31 offen offset:3072  lds
s_waitcnt lgkmcnt(4)
v_mfma_f32_16x16x32_bf16 v[128:131], a[32:35], v[192:195], v[128:131]
v_mfma_f32_16x16x32_bf16 v[128:131], a[48:51], v[196:199], v[128:131]
ds_read_b128 v[208:211], v15 offset:0
s_xor_b32 s31, s20, 917504
s_waitcnt lgkmcnt(3)
v_mfma_f32_16x16x32_bf16 v[144:147], a[48:51], v[200:203], v[144:147]
ds_read_b128 v[212:215], v15 offset:8192
s_add_u32 m0, s71, 114688
v_mfma_f32_16x16x32_bf16 v[144:147], a[32:35], v[204:207], v[144:147]
buffer_load_dwordx4 v60, s[48:51], s31 offen offset:0  lds
v_mfma_f32_16x16x32_bf16 v[148:151], a[36:39], v[204:207], v[148:151]
ds_read_b128 v[216:219], v15 offset:9216
v_mfma_f32_16x16x32_bf16 v[148:151], a[52:55], v[200:203], v[148:151]
ds_read_b128 v[220:223], v15 offset:1024
v_mfma_f32_16x16x32_bf16 v[132:135], a[52:55], v[196:199], v[132:135]
v_mfma_f32_16x16x32_bf16 v[132:135], a[36:39], v[192:195], v[132:135]
buffer_load_dwordx4 v61, s[48:51], s31 offen offset:1024  lds
v_mfma_f32_16x16x32_bf16 v[136:139], a[40:43], v[192:195], v[136:139]
v_mfma_f32_16x16x32_bf16 v[136:139], a[56:59], v[196:199], v[136:139]
s_waitcnt vmcnt(11)
ds_read_b64_tr_b16 a[240:241], v58 offset:32768
s_add_u32 m0, s65, 16384
v_mfma_f32_16x16x32_bf16 v[152:155], a[56:59], v[200:203], v[152:155]
buffer_load_dwordx4 v3, s[16:19], s30 offen offset:0 sc1 lds
v_mfma_f32_16x16x32_bf16 v[152:155], a[40:43], v[204:207], v[152:155]
ds_read_b64_tr_b16 a[242:243], v58 offset:34816
v_mfma_f32_16x16x32_bf16 v[156:159], a[44:47], v[204:207], v[156:159]
ds_read_b64_tr_b16 a[244:245], v59 offset:32768
v_mfma_f32_16x16x32_bf16 v[156:159], a[60:63], v[200:203], v[156:159]
ds_read_b64_tr_b16 a[246:247], v59 offset:34816
v_mfma_f32_16x16x32_bf16 v[140:143], a[60:63], v[196:199], v[140:143]
buffer_load_dwordx4 v3, s[16:19], s30 offen offset:1024 sc1 lds
v_mfma_f32_16x16x32_bf16 v[140:143], a[44:47], v[192:195], v[140:143]
ds_read_b64_tr_b16 a[248:249], v58 offset:33280
s_xor_b32 s30, s21, 122880
s_waitcnt lgkmcnt(5)
v_mfma_f32_16x16x32_bf16 v[160:163], a[32:35], v[208:211], v[160:163]
s_barrier
v_mfma_f32_16x16x32_bf16 v[160:163], a[48:51], v[212:215], v[160:163]
ds_read_b128 v[192:195], v14 offset:16384
s_add_u32 m0, s65, 24576
v_mfma_f32_16x16x32_bf16 v[176:179], a[48:51], v[216:219], v[176:179]
buffer_load_dwordx4 v3, s[16:19], s30 offen offset:0 sc1 lds
v_mfma_f32_16x16x32_bf16 v[176:179], a[32:35], v[220:223], v[176:179]
ds_read_b128 v[196:199], v14 offset:24576
v_mfma_f32_16x16x32_bf16 v[180:183], a[36:39], v[220:223], v[180:183]
ds_read_b128 v[200:203], v14 offset:25600
v_mfma_f32_16x16x32_bf16 v[180:183], a[52:55], v[216:219], v[180:183]
ds_read_b128 v[204:207], v14 offset:17408
v_mfma_f32_16x16x32_bf16 v[164:167], a[52:55], v[212:215], v[164:167]
buffer_load_dwordx4 v3, s[16:19], s30 offen offset:1024 sc1 lds
v_mfma_f32_16x16x32_bf16 v[164:167], a[36:39], v[208:211], v[164:167]
s_waitcnt vmcnt(12)
v_cmp_gt_u32 vcc, 1, v10
s_cbranch_vccnz P8_spin
P8_ok:
s_xor_b32 s30, s21, 131072
v_mfma_f32_16x16x32_bf16 v[168:171], a[40:43], v[208:211], v[168:171]
ds_read_b64_tr_b16 a[250:251], v58 offset:35328
v_mfma_f32_16x16x32_bf16 v[168:171], a[56:59], v[212:215], v[168:171]
ds_read_b64_tr_b16 a[252:253], v59 offset:33280
s_add_u32 m0, s71, 114688
v_mfma_f32_16x16x32_bf16 v[184:187], a[56:59], v[216:219], v[184:187]
buffer_load_dwordx4 v62, s[48:51], s31 offen offset:2048  lds
v_mfma_f32_16x16x32_bf16 v[184:187], a[40:43], v[220:223], v[184:187]
ds_read_b64_tr_b16 a[254:255], v59 offset:35328
v_mfma_f32_16x16x32_bf16 v[188:191], a[44:47], v[220:223], v[188:191]
v_mfma_f32_16x16x32_bf16 v[188:191], a[60:63], v[216:219], v[188:191]
buffer_load_dwordx4 v63, s[48:51], s31 offen offset:3072  lds
v_mfma_f32_16x16x32_bf16 v[172:175], a[60:63], v[212:215], v[172:175]
v_mfma_f32_16x16x32_bf16 v[172:175], a[44:47], v[208:211], v[172:175]
s_xor_b32 s31, s20, 1048576
s_waitcnt lgkmcnt(3)
v_mfma_f32_16x16x32_bf16 v[128:131], a[64:67], v[192:195], v[128:131]
s_add_u32 m0, s71, 147456
v_mfma_f32_16x16x32_bf16 v[128:131], a[80:83], v[196:199], v[128:131]
buffer_load_dwordx4 v60, s[48:51], s31 offen offset:0  lds
v_mfma_f32_16x16x32_bf16 v[144:147], a[80:83], v[200:203], v[144:147]
ds_read_b128 v[208:211], v15 offset:16384
v_mfma_f32_16x16x32_bf16 v[144:147], a[64:67], v[204:207], v[144:147]
ds_read_b128 v[212:215], v15 offset:24576
v_mfma_f32_16x16x32_bf16 v[148:151], a[68:71], v[204:207], v[148:151]
ds_read_b128 v[216:219], v15 offset:25600
v_mfma_f32_16x16x32_bf16 v[148:151], a[84:87], v[200:203], v[148:151]
buffer_load_dwordx4 v61, s[48:51], s31 offen offset:1024  lds
v_mfma_f32_16x16x32_bf16 v[132:135], a[84:87], v[196:199], v[132:135]
ds_read_b128 v[220:223], v15 offset:17408
v_mfma_f32_16x16x32_bf16 v[132:135], a[68:71], v[192:195], v[132:135]
s_waitcnt vmcnt(10)
ds_read_b64_tr_b16 a[0:1], v58 offset:0
v_mfma_f32_16x16x32_bf16 v[136:139], a[72:75], v[192:195], v[136:139]
ds_read_b64_tr_b16 a[2:3], v58 offset:2048
s_add_u32 m0, s65, 32768
v_mfma_f32_16x16x32_bf16 v[136:139], a[88:91], v[196:199], v[136:139]
buffer_load_dwordx4 v3, s[16:19], s30 offen offset:0 sc1 lds
v_mfma_f32_16x16x32_bf16 v[152:155], a[88:91], v[200:203], v[152:155]
ds_read_b64_tr_b16 a[4:5], v59 offset:0
v_mfma_f32_16x16x32_bf16 v[152:155], a[72:75], v[204:207], v[152:155]
ds_read_b64_tr_b16 a[6:7], v59 offset:2048
v_mfma_f32_16x16x32_bf16 v[156:159], a[76:79], v[204:207], v[156:159]
ds_read_b64_tr_b16 a[8:9], v58 offset:512
v_mfma_f32_16x16x32_bf16 v[156:159], a[92:95], v[200:203], v[156:159]
buffer_load_dwordx4 v3, s[16:19], s30 offen offset:1024 sc1 lds
v_mfma_f32_16x16x32_bf16 v[140:143], a[92:95], v[196:199], v[140:143]
ds_read_b64_tr_b16 a[10:11], v58 offset:2560
s_xor_b32 s30, s21, 139264
v_mfma_f32_16x16x32_bf16 v[140:143], a[76:79], v[192:195], v[140:143]
ds_read_b64_tr_b16 a[12:13], v59 offset:512
s_waitcnt lgkmcnt(7)
v_mfma_f32_16x16x32_bf16 v[160:163], a[64:67], v[208:211], v[160:163]
s_barrier
s_add_u32 m0, s65, 40960
v_mfma_f32_16x16x32_bf16 v[160:163], a[80:83], v[212:215], v[160:163]
buffer_load_dwordx4 v3, s[16:19], s30 offen offset:0 sc1 lds
v_mfma_f32_16x16x32_bf16 v[176:179], a[80:83], v[216:219], v[176:179]
ds_read_b128 v[192:195], v12 offset:0
v_mfma_f32_16x16x32_bf16 v[176:179], a[64:67], v[220:223], v[176:179]
ds_read_b128 v[196:199], v12 offset:8192
v_mfma_f32_16x16x32_bf16 v[180:183], a[68:71], v[220:223], v[180:183]
buffer_load_dwordx4 v3, s[16:19], s30 offen offset:1024 sc1 lds
v_mfma_f32_16x16x32_bf16 v[180:183], a[84:87], v[216:219], v[180:183]
ds_read_b128 v[200:203], v12 offset:9216
s_xor_b32 s30, s21, 147456
v_mfma_f32_16x16x32_bf16 v[164:167], a[84:87], v[212:215], v[164:167]
ds_read_b128 v[204:207], v12 offset:1024
v_mfma_f32_16x16x32_bf16 v[164:167], a[68:71], v[208:211], v[164:167]
ds_read_b64_tr_b16 a[14:15], v59 offset:2560
s_add_u32 m0, s71, 147456
v_mfma_f32_16x16x32_bf16 v[168:171], a[72:75], v[208:211], v[168:171]
buffer_load_dwordx4 v62, s[48:51], s31 offen offset:2048  lds
v_mfma_f32_16x16x32_bf16 v[168:171], a[88:91], v[212:215], v[168:171]
v_mfma_f32_16x16x32_bf16 v[184:187], a[88:91], v[216:219], v[184:187]
v_mfma_f32_16x16x32_bf16 v[184:187], a[72:75], v[220:223], v[184:187]
v_mfma_f32_16x16x32_bf16 v[188:191], a[76:79], v[220:223], v[188:191]
buffer_load_dwordx4 v63, s[48:51], s31 offen offset:3072  lds
v_mfma_f32_16x16x32_bf16 v[188:191], a[92:95], v[216:219], v[188:191]
v_mfma_f32_16x16x32_bf16 v[172:175], a[92:95], v[212:215], v[172:175]
s_xor_b32 s31, s20, 1179648
v_mfma_f32_16x16x32_bf16 v[172:175], a[76:79], v[208:211], v[172:175]
s_add_u32 m0, s71, 131072
s_waitcnt lgkmcnt(3)
v_mfma_f32_16x16x32_bf16 v[128:131], a[96:99], v[192:195], v[128:131]
buffer_load_dwordx4 v60, s[48:51], s31 offen offset:0  lds
v_mfma_f32_16x16x32_bf16 v[128:131], a[112:115], v[196:199], v[128:131]
ds_read_b128 v[208:211], v13 offset:0
s_waitcnt lgkmcnt(2)
v_mfma_f32_16x16x32_bf16 v[144:147], a[112:115], v[200:203], v[144:147]
ds_read_b128 v[212:215], v13 offset:8192
v_mfma_f32_16x16x32_bf16 v[144:147], a[96:99], v[204:207], v[144:147]
buffer_load_dwordx4 v61, s[48:51], s31 offen offset:1024  lds
v_mfma_f32_16x16x32_bf16 v[148:151], a[100:103], v[204:207], v[148:151]
ds_read_b128 v[216:219], v13 offset:9216
v_mfma_f32_16x16x32_bf16 v[148:151], a[116:119], v[200:203], v[148:151]
ds_read_b128 v[220:223], v13 offset:1024
v_mfma_f32_16x16x32_bf16 v[132:135], a[116:119], v[196:199], v[132:135]
s_waitcnt vmcnt(10)
ds_read_b64_tr_b16 a[16:17], v58 offset:16384
s_add_u32 m0, s65, 49152
v_mfma_f32_16x16x32_bf16 v[132:135], a[100:103], v[192:195], v[132:135]
buffer_load_dwordx4 v3, s[16:19], s30 offen offset:0 sc1 lds
v_mfma_f32_16x16x32_bf16 v[136:139], a[104:107], v[192:195], v[136:139]
ds_read_b64_tr_b16 a[18:19], v58 offset:18432
v_mfma_f32_16x16x32_bf16 v[136:139], a[120:123], v[196:199], v[136:139]
ds_read_b64_tr_b16 a[20:21], v59 offset:16384
v_mfma_f32_16x16x32_bf16 v[152:155], a[120:123], v[200:203], v[152:155]
ds_read_b64_tr_b16 a[22:23], v59 offset:18432
v_mfma_f32_16x16x32_bf16 v[152:155], a[104:107], v[204:207], v[152:155]
buffer_load_dwordx4 v3, s[16:19], s30 offen offset:1024 sc1 lds
v_mfma_f32_16x16x32_bf16 v[156:159], a[108:111], v[204:207], v[156:159]
ds_read_b64_tr_b16 a[24:25], v58 offset:16896
s_xor_b32 s30, s21, 155648
v_mfma_f32_16x16x32_bf16 v[156:159], a[124:127], v[200:203], v[156:159]
ds_read_b64_tr_b16 a[26:27], v58 offset:18944
v_mfma_f32_16x16x32_bf16 v[140:143], a[124:127], v[196:199], v[140:143]
ds_read_b64_tr_b16 a[28:29], v59 offset:16896
s_add_u32 m0, s65, 57344
v_mfma_f32_16x16x32_bf16 v[140:143], a[108:111], v[192:195], v[140:143]
buffer_load_dwordx4 v3, s[16:19], s30 offen offset:0 sc1 lds
s_waitcnt lgkmcnt(6)
v_mfma_f32_16x16x32_bf16 v[160:163], a[96:99], v[208:211], v[160:163]
s_barrier
v_mfma_f32_16x16x32_bf16 v[160:163], a[112:115], v[212:215], v[160:163]
ds_read_b128 v[192:195], v12 offset:16384
v_mfma_f32_16x16x32_bf16 v[176:179], a[112:115], v[216:219], v[176:179]
ds_read_b128 v[196:199], v12 offset:24576
v_mfma_f32_16x16x32_bf16 v[176:179], a[96:99], v[220:223], v[176:179]
buffer_load_dwordx4 v3, s[16:19], s30 offen offset:1024 sc1 lds
v_mfma_f32_16x16x32_bf16 v[180:183], a[100:103], v[220:223], v[180:183]
ds_read_b128 v[200:203], v12 offset:25600
s_xor_b32 s30, s21, 163840
v_mfma_f32_16x16x32_bf16 v[180:183], a[116:119], v[216:219], v[180:183]
ds_read_b128 v[204:207], v12 offset:17408
s_add_u32 m0, s71, 131072
v_mfma_f32_16x16x32_bf16 v[164:167], a[116:119], v[212:215], v[164:167]
buffer_load_dwordx4 v62, s[48:51], s31 offen offset:2048  lds
v_mfma_f32_16x16x32_bf16 v[164:167], a[100:103], v[208:211], v[164:167]
ds_read_b64_tr_b16 a[30:31], v59 offset:18944
v_mfma_f32_16x16x32_bf16 v[168:171], a[104:107], v[208:211], v[168:171]
v_mfma_f32_16x16x32_bf16 v[168:171], a[120:123], v[212:215], v[168:171]
v_mfma_f32_16x16x32_bf16 v[184:187], a[120:123], v[216:219], v[184:187]
buffer_load_dwordx4 v63, s[48:51], s31 offen offset:3072  lds
v_mfma_f32_16x16x32_bf16 v[184:187], a[104:107], v[220:223], v[184:187]
v_mfma_f32_16x16x32_bf16 v[188:191], a[108:111], v[220:223], v[188:191]
s_xor_b32 s31, s20, 1310720
v_mfma_f32_16x16x32_bf16 v[188:191], a[124:127], v[216:219], v[188:191]
s_add_u32 m0, s71, 98304
v_mfma_f32_16x16x32_bf16 v[172:175], a[124:127], v[212:215], v[172:175]
buffer_load_dwordx4 v60, s[48:51], s31 offen offset:0  lds
v_mfma_f32_16x16x32_bf16 v[172:175], a[108:111], v[208:211], v[172:175]
s_waitcnt lgkmcnt(2)
v_mfma_f32_16x16x32_bf16 v[128:131], a[128:131], v[192:195], v[128:131]
v_mfma_f32_16x16x32_bf16 v[128:131], a[144:147], v[196:199], v[128:131]
ds_read_b128 v[208:211], v13 offset:16384
v_mfma_f32_16x16x32_bf16 v[144:147], a[144:147], v[200:203], v[144:147]
buffer_load_dwordx4 v61, s[48:51], s31 offen offset:1024  lds
s_waitcnt lgkmcnt(2)
v_mfma_f32_16x16x32_bf16 v[144:147], a[128:131], v[204:207], v[144:147]
ds_read_b128 v[212:215], v13 offset:24576
v_mfma_f32_16x16x32_bf16 v[148:151], a[132:135], v[204:207], v[148:151]
ds_read_b128 v[216:219], v13 offset:25600
v_mfma_f32_16x16x32_bf16 v[148:151], a[148:151], v[200:203], v[148:151]
ds_read_b128 v[220:223], v13 offset:17408
s_add_u32 m0, s65, 65536
v_mfma_f32_16x16x32_bf16 v[132:135], a[148:151], v[196:199], v[132:135]
buffer_load_dwordx4 v3, s[16:19], s30 offen offset:0 sc1 lds
v_mfma_f32_16x16x32_bf16 v[132:135], a[132:135], v[192:195], v[132:135]
s_waitcnt vmcnt(11)
ds_read_b64_tr_b16 a[32:33], v58 offset:49152
v_mfma_f32_16x16x32_bf16 v[136:139], a[136:139], v[192:195], v[136:139]
ds_read_b64_tr_b16 a[34:35], v58 offset:51200
v_mfma_f32_16x16x32_bf16 v[136:139], a[152:155], v[196:199], v[136:139]
buffer_load_dwordx4 v3, s[16:19], s30 offen offset:1024 sc1 lds
v_mfma_f32_16x16x32_bf16 v[152:155], a[152:155], v[200:203], v[152:155]
ds_read_b64_tr_b16 a[36:37], v59 offset:49152
s_xor_b32 s30, s21, 172032
v_mfma_f32_16x16x32_bf16 v[152:155], a[136:139], v[204:207], v[152:155]
ds_read_b64_tr_b16 a[38:39], v59 offset:51200
v_mfma_f32_16x16x32_bf16 v[156:159], a[140:143], v[204:207], v[156:159]
ds_read_b64_tr_b16 a[40:41], v58 offset:49664
s_add_u32 m0, s65, 73728
v_mfma_f32_16x16x32_bf16 v[156:159], a[156:159], v[200:203], v[156:159]
buffer_load_dwordx4 v3, s[16:19], s30 offen offset:0 sc1 lds
v_mfma_f32_16x16x32_bf16 v[140:143], a[156:159], v[196:199], v[140:143]
ds_read_b64_tr_b16 a[42:43], v58 offset:51712
v_mfma_f32_16x16x32_bf16 v[140:143], a[140:143], v[192:195], v[140:143]
ds_read_b64_tr_b16 a[44:45], v59 offset:49664
s_waitcnt lgkmcnt(7)
v_mfma_f32_16x16x32_bf16 v[160:163], a[128:131], v[208:211], v[160:163]
s_barrier
v_mfma_f32_16x16x32_bf16 v[160:163], a[144:147], v[212:215], v[160:163]
buffer_load_dwordx4 v3, s[16:19], s30 offen offset:1024 sc1 lds
v_mfma_f32_16x16x32_bf16 v[176:179], a[144:147], v[216:219], v[176:179]
ds_read_b128 v[192:195], v12 offset:32768
s_xor_b32 s30, s21, 180224
v_mfma_f32_16x16x32_bf16 v[176:179], a[128:131], v[220:223], v[176:179]
ds_read_b128 v[196:199], v12 offset:40960
v_mfma_f32_16x16x32_bf16 v[180:183], a[132:135], v[220:223], v[180:183]
ds_read_b128 v[200:203], v12 offset:41984
s_add_u32 m0, s71, 98304
v_mfma_f32_16x16x32_bf16 v[180:183], a[148:151], v[216:219], v[180:183]
buffer_load_dwordx4 v62, s[48:51], s31 offen offset:2048  lds
v_mfma_f32_16x16x32_bf16 v[164:167], a[148:151], v[212:215], v[164:167]
ds_read_b128 v[204:207], v12 offset:33792
v_mfma_f32_16x16x32_bf16 v[164:167], a[132:135], v[208:211], v[164:167]
ds_read_b64_tr_b16 a[46:47], v59 offset:51712
v_mfma_f32_16x16x32_bf16 v[168:171], a[136:139], v[208:211], v[168:171]
v_mfma_f32_16x16x32_bf16 v[168:171], a[152:155], v[212:215], v[168:171]
buffer_load_dwordx4 v63, s[48:51], s31 offen offset:3072  lds
v_mfma_f32_16x16x32_bf16 v[184:187], a[152:155], v[216:219], v[184:187]
s_xor_b32 s31, s20, 1441792
v_mfma_f32_16x16x32_bf16 v[184:187], a[136:139], v[220:223], v[184:187]
s_add_u32 m0, s71, 114688
v_mfma_f32_16x16x32_bf16 v[188:191], a[140:143], v[220:223], v[188:191]
buffer_load_dwordx4 v60, s[48:51], s31 offen offset:0  lds
v_mfma_f32_16x16x32_bf16 v[188:191], a[156:159], v[216:219], v[188:191]
v_mfma_f32_16x16x32_bf16 v[172:175], a[156:159], v[212:215], v[172:175]
v_mfma_f32_16x16x32_bf16 v[172:175], a[140:143], v[208:211], v[172:175]
s_waitcnt lgkmcnt(2)
v_mfma_f32_16x16x32_bf16 v[128:131], a[160:163], v[192:195], v[128:131]
buffer_load_dwordx4 v61, s[48:51], s31 offen offset:1024  lds
v_mfma_f32_16x16x32_bf16 v[128:131], a[176:179], v[196:199], v[128:131]
ds_read_b128 v[208:211], v13 offset:32768
v_mfma_f32_16x16x32_bf16 v[144:147], a[176:179], v[200:203], v[144:147]
ds_read_b128 v[212:215], v13 offset:40960
s_waitcnt lgkmcnt(2)
v_mfma_f32_16x16x32_bf16 v[144:147], a[160:163], v[204:207], v[144:147]
ds_read_b128 v[216:219], v13 offset:41984
s_add_u32 m0, s71, 114688
v_mfma_f32_16x16x32_bf16 v[148:151], a[164:167], v[204:207], v[148:151]
buffer_load_dwordx4 v62, s[48:51], s31 offen offset:2048  lds
v_mfma_f32_16x16x32_bf16 v[148:151], a[180:183], v[200:203], v[148:151]
ds_read_b128 v[220:223], v13 offset:33792
v_mfma_f32_16x16x32_bf16 v[132:135], a[180:183], v[196:199], v[132:135]
s_waitcnt vmcnt(11)
ds_read_b64_tr_b16 a[48:49], v58 offset:32768
v_mfma_f32_16x16x32_bf16 v[132:135], a[164:167], v[192:195], v[132:135]
ds_read_b64_tr_b16 a[50:51], v58 offset:34816
v_mfma_f32_16x16x32_bf16 v[136:139], a[168:171], v[192:195], v[136:139]
buffer_load_dwordx4 v63, s[48:51], s31 offen offset:3072  lds
v_mfma_f32_16x16x32_bf16 v[136:139], a[184:187], v[196:199], v[136:139]
ds_read_b64_tr_b16 a[52:53], v59 offset:32768
v_mfma_f32_16x16x32_bf16 v[152:155], a[184:187], v[200:203], v[152:155]
ds_read_b64_tr_b16 a[54:55], v59 offset:34816
v_mfma_f32_16x16x32_bf16 v[152:155], a[168:171], v[204:207], v[152:155]
ds_read_b64_tr_b16 a[56:57], v58 offset:33280
s_add_u32 m0, s65, 81920
v_mfma_f32_16x16x32_bf16 v[156:159], a[172:175], v[204:207], v[156:159]
buffer_load_dwordx4 v3, s[16:19], s30 offen offset:0 sc1 lds
v_mfma_f32_16x16x32_bf16 v[156:159], a[188:191], v[200:203], v[156:159]
ds_read_b64_tr_b16 a[58:59], v58 offset:35328
v_mfma_f32_16x16x32_bf16 v[140:143], a[188:191], v[196:199], v[140:143]
ds_read_b64_tr_b16 a[60:61], v59 offset:33280
v_mfma_f32_16x16x32_bf16 v[140:143], a[172:175], v[192:195], v[140:143]
buffer_load_dwordx4 v3, s[16:19], s30 offen offset:1024 sc1 lds
s_waitcnt lgkmcnt(6)
v_mfma_f32_16x16x32_bf16 v[160:163], a[160:163], v[208:211], v[160:163]
s_barrier
s_xor_b32 s30, s21, 188416
v_mfma_f32_16x16x32_bf16 v[160:163], a[176:179], v[212:215], v[160:163]
ds_read_b128 v[192:195], v12 offset:49152
v_mfma_f32_16x16x32_bf16 v[176:179], a[176:179], v[216:219], v[176:179]
ds_read_b128 v[196:199], v12 offset:57344
s_add_u32 m0, s65, 90112
v_mfma_f32_16x16x32_bf16 v[176:179], a[160:163], v[220:223], v[176:179]
buffer_load_dwordx4 v3, s[16:19], s30 offen offset:0 sc1 lds
v_mfma_f32_16x16x32_bf16 v[180:183], a[164:167], v[220:223], v[180:183]
ds_read_b128 v[200:203], v12 offset:58368
v_mfma_f32_16x16x32_bf16 v[180:183], a[180:183], v[216:219], v[180:183]
ds_read_b128 v[204:207], v12 offset:50176
v_mfma_f32_16x16x32_bf16 v[164:167], a[180:183], v[212:215], v[164:167]
ds_read_b64_tr_b16 a[62:63], v59 offset:35328
v_mfma_f32_16x16x32_bf16 v[164:167], a[164:167], v[208:211], v[164:167]
buffer_load_dwordx4 v3, s[16:19], s30 offen offset:1024 sc1 lds
v_mfma_f32_16x16x32_bf16 v[168:171], a[168:171], v[208:211], v[168:171]
s_xor_b32 s30, s21, 196608
v_mfma_f32_16x16x32_bf16 v[168:171], a[184:187], v[212:215], v[168:171]
s_xor_b32 s31, s20, 1572864
v_mfma_f32_16x16x32_bf16 v[184:187], a[184:187], v[216:219], v[184:187]
s_add_u32 m0, s71, 147456
v_mfma_f32_16x16x32_bf16 v[184:187], a[168:171], v[220:223], v[184:187]
buffer_load_dwordx4 v60, s[48:51], s31 offen offset:0  lds
v_mfma_f32_16x16x32_bf16 v[188:191], a[172:175], v[220:223], v[188:191]
v_mfma_f32_16x16x32_bf16 v[188:191], a[188:191], v[216:219], v[188:191]
v_mfma_f32_16x16x32_bf16 v[172:175], a[188:191], v[212:215], v[172:175]
v_mfma_f32_16x16x32_bf16 v[172:175], a[172:175], v[208:211], v[172:175]
buffer_load_dwordx4 v61, s[48:51], s31 offen offset:1024  lds
s_waitcnt lgkmcnt(2)
v_mfma_f32_16x16x32_bf16 v[128:131], a[192:195], v[192:195], v[128:131]
v_mfma_f32_16x16x32_bf16 v[128:131], a[208:211], v[196:199], v[128:131]
ds_read_b128 v[208:211], v13 offset:49152
s_add_u32 m0, s71, 147456
v_mfma_f32_16x16x32_bf16 v[144:147], a[208:211], v[200:203], v[144:147]
buffer_load_dwordx4 v62, s[48:51], s31 offen offset:2048  lds
s_waitcnt lgkmcnt(1)
v_mfma_f32_16x16x32_bf16 v[144:147], a[192:195], v[204:207], v[144:147]
ds_read_b128 v[212:215], v13 offset:57344
v_mfma_f32_16x16x32_bf16 v[148:151], a[196:199], v[204:207], v[148:151]
ds_read_b128 v[216:219], v13 offset:58368
v_mfma_f32_16x16x32_bf16 v[148:151], a[212:215], v[200:203], v[148:151]
ds_read_b128 v[220:223], v13 offset:50176
v_mfma_f32_16x16x32_bf16 v[132:135], a[212:215], v[196:199], v[132:135]
buffer_load_dwordx4 v63, s[48:51], s31 offen offset:3072  lds
v_mfma_f32_16x16x32_bf16 v[132:135], a[196:199], v[192:195], v[132:135]
s_waitcnt vmcnt(12)
ds_read_b64_tr_b16 a[64:65], v58 offset:0
v_mfma_f32_16x16x32_bf16 v[136:139], a[200:203], v[192:195], v[136:139]
ds_read_b64_tr_b16 a[66:67], v58 offset:2048
v_mfma_f32_16x16x32_bf16 v[136:139], a[216:219], v[196:199], v[136:139]
ds_read_b64_tr_b16 a[68:69], v59 offset:0
s_add_u32 m0, s65, 0
v_mfma_f32_16x16x32_bf16 v[152:155], a[216:219], v[200:203], v[152:155]
buffer_load_dwordx4 v3, s[16:19], s30 offen offset:0 sc1 lds
v_mfma_f32_16x16x32_bf16 v[152:155], a[200:203], v[204:207], v[152:155]
ds_read_b64_tr_b16 a[70:71], v59 offset:2048
v_mfma_f32_16x16x32_bf16 v[156:159], a[204:207], v[204:207], v[156:159]
ds_read_b64_tr_b16 a[72:73], v58 offset:512
v_mfma_f32_16x16x32_bf16 v[156:159], a[220:223], v[200:203], v[156:159]
ds_read_b64_tr_b16 a[74:75], v58 offset:2560
v_mfma_f32_16x16x32_bf16 v[140:143], a[220:223], v[196:199], v[140:143]
buffer_load_dwordx4 v3, s[16:19], s30 offen offset:1024 sc1 lds
v_mfma_f32_16x16x32_bf16 v[140:143], a[204:207], v[192:195], v[140:143]
ds_read_b64_tr_b16 a[76:77], v59 offset:512
s_xor_b32 s30, s21, 204800
s_waitcnt lgkmcnt(7)
v_mfma_f32_16x16x32_bf16 v[160:163], a[192:195], v[208:211], v[160:163]
s_barrier
v_mfma_f32_16x16x32_bf16 v[160:163], a[208:211], v[212:215], v[160:163]
ds_read_b128 v[192:195], v14 offset:0
s_add_u32 m0, s65, 8192
v_mfma_f32_16x16x32_bf16 v[176:179], a[208:211], v[216:219], v[176:179]
buffer_load_dwordx4 v3, s[16:19], s30 offen offset:0 sc1 lds
v_mfma_f32_16x16x32_bf16 v[176:179], a[192:195], v[220:223], v[176:179]
ds_read_b128 v[196:199], v14 offset:8192
v_mfma_f32_16x16x32_bf16 v[180:183], a[196:199], v[220:223], v[180:183]
ds_read_b128 v[200:203], v14 offset:9216
v_mfma_f32_16x16x32_bf16 v[180:183], a[212:215], v[216:219], v[180:183]
buffer_load_dwordx4 v3, s[16:19], s30 offen offset:1024 sc1 lds
v_mfma_f32_16x16x32_bf16 v[164:167], a[212:215], v[212:215], v[164:167]
ds_read_b128 v[204:207], v14 offset:1024
s_xor_b32 s30, s21, 212992
v_mfma_f32_16x16x32_bf16 v[164:167], a[196:199], v[208:211], v[164:167]
ds_read_b64_tr_b16 a[78:79], v59 offset:2560
s_xor_b32 s31, s20, 1703936
v_mfma_f32_16x16x32_bf16 v[168:171], a[200:203], v[208:211], v[168:171]
s_waitcnt vmcnt(12)
ds_read_b64_tr_b16 a[80:81], v58 offset:16384
s_add_u32 m0, s71, 131072
v_mfma_f32_16x16x32_bf16 v[168:171], a[216:219], v[212:215], v[168:171]
buffer_load_dwordx4 v60, s[48:51], s31 offen offset:0  lds
v_mfma_f32_16x16x32_bf16 v[184:187], a[216:219], v[216:219], v[184:187]
ds_read_b64_tr_b16 a[82:83], v58 offset:18432
v_mfma_f32_16x16x32_bf16 v[184:187], a[200:203], v[220:223], v[184:187]
ds_read_b64_tr_b16 a[84:85], v59 offset:16384
v_mfma_f32_16x16x32_bf16 v[188:191], a[204:207], v[220:223], v[188:191]
ds_read_b64_tr_b16 a[86:87], v59 offset:18432
v_mfma_f32_16x16x32_bf16 v[188:191], a[220:223], v[216:219], v[188:191]
buffer_load_dwordx4 v61, s[48:51], s31 offen offset:1024  lds
v_mfma_f32_16x16x32_bf16 v[172:175], a[220:223], v[212:215], v[172:175]
ds_read_b64_tr_b16 a[88:89], v58 offset:16896
v_mfma_f32_16x16x32_bf16 v[172:175], a[204:207], v[208:211], v[172:175]
ds_read_b64_tr_b16 a[90:91], v58 offset:18944
s_waitcnt lgkmcnt(6)
v_mfma_f32_16x16x32_bf16 v[128:131], a[224:227], v[192:195], v[128:131]
ds_read_b64_tr_b16 a[92:93], v59 offset:16896
s_add_u32 m0, s71, 131072
v_mfma_f32_16x16x32_bf16 v[128:131], a[240:243], v[196:199], v[128:131]
buffer_load_dwordx4 v62, s[48:51], s31 offen offset:2048  lds
v_mfma_f32_16x16x32_bf16 v[144:147], a[240:243], v[200:203], v[144:147]
ds_read_b128 v[208:211], v15 offset:0
v_mfma_f32_16x16x32_bf16 v[144:147], a[224:227], v[204:207], v[144:147]
ds_read_b128 v[212:215], v15 offset:8192
v_mfma_f32_16x16x32_bf16 v[148:151], a[228:231], v[204:207], v[148:151]
ds_read_b128 v[216:219], v15 offset:9216
v_mfma_f32_16x16x32_bf16 v[148:151], a[244:247], v[200:203], v[148:151]
buffer_load_dwordx4 v63, s[48:51], s31 offen offset:3072  lds
v_mfma_f32_16x16x32_bf16 v[132:135], a[244:247], v[196:199], v[132:135]
ds_read_b128 v[220:223], v15 offset:1024
v_mfma_f32_16x16x32_bf16 v[132:135], a[228:231], v[192:195], v[132:135]
ds_read_b64_tr_b16 a[94:95], v59 offset:18944
s_add_u32 m0, s65, 16384
v_mfma_f32_16x16x32_bf16 v[136:139], a[232:235], v[192:195], v[136:139]
buffer_load_dwordx4 v3, s[16:19], s30 offen offset:0 sc1 lds
v_mfma_f32_16x16x32_bf16 v[136:139], a[248:251], v[196:199], v[136:139]
v_mfma_f32_16x16x32_bf16 v[152:155], a[248:251], v[200:203], v[152:155]
v_mfma_f32_16x16x32_bf16 v[152:155], a[232:235], v[204:207], v[152:155]
v_mfma_f32_16x16x32_bf16 v[156:159], a[236:239], v[204:207], v[156:159]
buffer_load_dwordx4 v3, s[16:19], s30 offen offset:1024 sc1 lds
v_mfma_f32_16x16x32_bf16 v[156:159], a[252:255], v[200:203], v[156:159]
s_xor_b32 s30, s21, 221184
v_mfma_f32_16x16x32_bf16 v[140:143], a[252:255], v[196:199], v[140:143]
s_waitcnt vmcnt(10)
ds_read_b64_tr_b16 a[96:97], v58 offset:49152
v_mfma_f32_16x16x32_bf16 v[140:143], a[236:239], v[192:195], v[140:143]
ds_read_b64_tr_b16 a[98:99], v58 offset:51200
s_waitcnt lgkmcnt(4)
v_mfma_f32_16x16x32_bf16 v[160:163], a[224:227], v[208:211], v[160:163]
s_barrier
s_add_u32 m0, s65, 24576
v_mfma_f32_16x16x32_bf16 v[160:163], a[240:243], v[212:215], v[160:163]
buffer_load_dwordx4 v3, s[16:19], s30 offen offset:0 sc1 lds
v_mfma_f32_16x16x32_bf16 v[176:179], a[240:243], v[216:219], v[176:179]
ds_read_b128 v[192:195], v14 offset:16384
s_waitcnt lgkmcnt(3)
v_mfma_f32_16x16x32_bf16 v[176:179], a[224:227], v[220:223], v[176:179]
ds_read_b128 v[196:199], v14 offset:24576
v_mfma_f32_16x16x32_bf16 v[180:183], a[228:231], v[220:223], v[180:183]
buffer_load_dwordx4 v3, s[16:19], s30 offen offset:1024 sc1 lds
v_mfma_f32_16x16x32_bf16 v[180:183], a[244:247], v[216:219], v[180:183]
ds_read_b128 v[200:203], v14 offset:25600
s_xor_b32 s30, s21, 229376
v_mfma_f32_16x16x32_bf16 v[164:167], a[244:247], v[212:215], v[164:167]
ds_read_b128 v[204:207], v14 offset:17408
s_xor_b32 s31, s20, 1835008
v_mfma_f32_16x16x32_bf16 v[164:167], a[228:231], v[208:211], v[164:167]
ds_read_b64_tr_b16 a[100:101], v59 offset:49152
s_add_u32 m0, s71, 98304
v_mfma_f32_16x16x32_bf16 v[168:171], a[232:235], v[208:211], v[168:171]
buffer_load_dwordx4 v60, s[48:51], s31 offen offset:0  lds
v_mfma_f32_16x16x32_bf16 v[168:171], a[248:251], v[212:215], v[168:171]
ds_read_b64_tr_b16 a[102:103], v59 offset:51200
v_mfma_f32_16x16x32_bf16 v[184:187], a[248:251], v[216:219], v[184:187]
ds_read_b64_tr_b16 a[104:105], v58 offset:49664
v_mfma_f32_16x16x32_bf16 v[184:187], a[232:235], v[220:223], v[184:187]
buffer_load_dwordx4 v61, s[48:51], s31 offen offset:1024  lds
v_mfma_f32_16x16x32_bf16 v[188:191], a[236:239], v[220:223], v[188:191]
ds_read_b64_tr_b16 a[106:107], v58 offset:51712
v_mfma_f32_16x16x32_bf16 v[188:191], a[252:255], v[216:219], v[188:191]
ds_read_b64_tr_b16 a[108:109], v59 offset:49664
v_mfma_f32_16x16x32_bf16 v[172:175], a[252:255], v[212:215], v[172:175]
ds_read_b64_tr_b16 a[110:111], v59 offset:51712
s_add_u32 m0, s71, 98304
v_mfma_f32_16x16x32_bf16 v[172:175], a[236:239], v[208:211], v[172:175]
buffer_load_dwordx4 v62, s[48:51], s31 offen offset:2048  lds
s_waitcnt lgkmcnt(6)
v_mfma_f32_16x16x32_bf16 v[128:131], a[0:3], v[192:195], v[128:131]
v_mfma_f32_16x16x32_bf16 v[128:131], a[16:19], v[196:199], v[128:131]
ds_read_b128 v[208:211], v15 offset:16384
v_mfma_f32_16x16x32_bf16 v[144:147], a[16:19], v[200:203], v[144:147]
ds_read_b128 v[212:215], v15 offset:24576
v_mfma_f32_16x16x32_bf16 v[144:147], a[0:3], v[204:207], v[144:147]
buffer_load_dwordx4 v63, s[48:51], s31 offen offset:3072  lds
v_mfma_f32_16x16x32_bf16 v[148:151], a[4:7], v[204:207], v[148:151]
ds_read_b128 v[216:219], v15 offset:25600
v_mfma_f32_16x16x32_bf16 v[148:151], a[20:23], v[200:203], v[148:151]
ds_read_b128 v[220:223], v15 offset:17408
v_mfma_f32_16x16x32_bf16 v[132:135], a[20:23], v[196:199], v[132:135]
s_add_u32 m0, s65, 32768
v_mfma_f32_16x16x32_bf16 v[132:135], a[4:7], v[192:195], v[132:135]
buffer_load_dwordx4 v3, s[16:19], s30 offen offset:0 sc1 lds
v_mfma_f32_16x16x32_bf16 v[136:139], a[8:11], v[192:195], v[136:139]
v_mfma_f32_16x16x32_bf16 v[136:139], a[24:27], v[196:199], v[136:139]
v_mfma_f32_16x16x32_bf16 v[152:155], a[24:27], v[200:203], v[152:155]
v_mfma_f32_16x16x32_bf16 v[152:155], a[8:11], v[204:207], v[152:155]
buffer_load_dwordx4 v3, s[16:19], s30 offen offset:1024 sc1 lds
v_mfma_f32_16x16x32_bf16 v[156:159], a[12:15], v[204:207], v[156:159]
s_xor_b32 s30, s21, 237568
v_mfma_f32_16x16x32_bf16 v[156:159], a[28:31], v[200:203], v[156:159]
s_waitcnt vmcnt(10)
ds_read_b64_tr_b16 a[112:113], v58 offset:32768
s_add_u32 m0, s65, 40960
v_mfma_f32_16x16x32_bf16 v[140:143], a[28:31], v[196:199], v[140:143]
buffer_load_dwordx4 v3, s[16:19], s30 offen offset:0 sc1 lds
v_mfma_f32_16x16x32_bf16 v[140:143], a[12:15], v[192:195], v[140:143]
ds_read_b64_tr_b16 a[114:115], v58 offset:34816
s_waitcnt lgkmcnt(2)
v_mfma_f32_16x16x32_bf16 v[160:163], a[0:3], v[208:211], v[160:163]
s_barrier
v_mfma_f32_16x16x32_bf16 v[160:163], a[16:19], v[212:215], v[160:163]
ds_read_b128 v[192:195], v12 offset:0
v_mfma_f32_16x16x32_bf16 v[176:179], a[16:19], v[216:219], v[176:179]
buffer_load_dwordx4 v3, s[16:19], s30 offen offset:1024 sc1 lds
v_mfma_f32_16x16x32_bf16 v[176:179], a[0:3], v[220:223], v[176:179]
ds_read_b128 v[196:199], v12 offset:8192
s_xor_b32 s30, s21, 245760
v_mfma_f32_16x16x32_bf16 v[180:183], a[4:7], v[220:223], v[180:183]
ds_read_b128 v[200:203], v12 offset:9216
s_xor_b32 s31, s20, 1966080
v_mfma_f32_16x16x32_bf16 v[180:183], a[20:23], v[216:219], v[180:183]
ds_read_b128 v[204:207], v12 offset:1024
s_add_u32 m0, s71, 114688
v_mfma_f32_16x16x32_bf16 v[164:167], a[20:23], v[212:215], v[164:167]
buffer_load_dwordx4 v60, s[48:51], s31 offen offset:0  lds
v_mfma_f32_16x16x32_bf16 v[164:167], a[4:7], v[208:211], v[164:167]
ds_read_b64_tr_b16 a[116:117], v59 offset:32768
v_mfma_f32_16x16x32_bf16 v[168:171], a[8:11], v[208:211], v[168:171]
ds_read_b64_tr_b16 a[118:119], v59 offset:34816
v_mfma_f32_16x16x32_bf16 v[168:171], a[24:27], v[212:215], v[168:171]
ds_read_b64_tr_b16 a[120:121], v58 offset:33280
v_mfma_f32_16x16x32_bf16 v[184:187], a[24:27], v[216:219], v[184:187]
buffer_load_dwordx4 v61, s[48:51], s31 offen offset:1024  lds
v_mfma_f32_16x16x32_bf16 v[184:187], a[8:11], v[220:223], v[184:187]
ds_read_b64_tr_b16 a[122:123], v58 offset:35328
v_mfma_f32_16x16x32_bf16 v[188:191], a[12:15], v[220:223], v[188:191]
ds_read_b64_tr_b16 a[124:125], v59 offset:33280
v_mfma_f32_16x16x32_bf16 v[188:191], a[28:31], v[216:219], v[188:191]
ds_read_b64_tr_b16 a[126:127], v59 offset:35328
s_add_u32 m0, s65, 49152
v_mfma_f32_16x16x32_bf16 v[172:175], a[28:31], v[212:215], v[172:175]
buffer_load_dwordx4 v3, s[16:19], s30 offen offset:0 sc1 lds
v_mfma_f32_16x16x32_bf16 v[172:175], a[12:15], v[208:211], v[172:175]
s_waitcnt lgkmcnt(6)
v_mfma_f32_16x16x32_bf16 v[128:131], a[32:35], v[192:195], v[128:131]
v_mfma_f32_16x16x32_bf16 v[128:131], a[48:51], v[196:199], v[128:131]
buffer_load_dwordx4 v3, s[16:19], s30 offen offset:1024 sc1 lds
v_mfma_f32_16x16x32_bf16 v[144:147], a[48:51], v[200:203], v[144:147]
ds_read_b128 v[208:211], v13 offset:0
s_xor_b32 s30, s21, 253952
v_mfma_f32_16x16x32_bf16 v[144:147], a[32:35], v[204:207], v[144:147]
ds_read_b128 v[212:215], v13 offset:8192
v_mfma_f32_16x16x32_bf16 v[148:151], a[36:39], v[204:207], v[148:151]
ds_read_b128 v[216:219], v13 offset:9216
s_add_u32 m0, s65, 57344
v_mfma_f32_16x16x32_bf16 v[148:151], a[52:55], v[200:203], v[148:151]
buffer_load_dwordx4 v3, s[16:19], s30 offen offset:0 sc1 lds
v_mfma_f32_16x16x32_bf16 v[132:135], a[52:55], v[196:199], v[132:135]
ds_read_b128 v[220:223], v13 offset:1024
v_mfma_f32_16x16x32_bf16 v[132:135], a[36:39], v[192:195], v[132:135]
v_mfma_f32_16x16x32_bf16 v[136:139], a[40:43], v[192:195], v[136:139]
v_mfma_f32_16x16x32_bf16 v[136:139], a[56:59], v[196:199], v[136:139]
buffer_load_dwordx4 v3, s[16:19], s30 offen offset:1024 sc1 lds
v_mfma_f32_16x16x32_bf16 v[152:155], a[56:59], v[200:203], v[152:155]
s_xor_b32 s30, s21, 0
v_mfma_f32_16x16x32_bf16 v[152:155], a[40:43], v[204:207], v[152:155]
s_waitcnt vmcnt(10)
ds_read_b64_tr_b16 a[128:129], v58 offset:0
v_mfma_f32_16x16x32_bf16 v[156:159], a[44:47], v[204:207], v[156:159]
ds_read_b64_tr_b16 a[130:131], v58 offset:2048
s_add_u32 m0, s71, 114688
v_mfma_f32_16x16x32_bf16 v[156:159], a[60:63], v[200:203], v[156:159]
buffer_load_dwordx4 v62, s[48:51], s31 offen offset:2048  lds
v_mfma_f32_16x16x32_bf16 v[140:143], a[60:63], v[196:199], v[140:143]
ds_read_b64_tr_b16 a[132:133], v59 offset:0
v_mfma_f32_16x16x32_bf16 v[140:143], a[44:47], v[192:195], v[140:143]
ds_read_b64_tr_b16 a[134:135], v59 offset:2048
s_waitcnt lgkmcnt(5)
v_mfma_f32_16x16x32_bf16 v[160:163], a[32:35], v[208:211], v[160:163]
s_barrier
v_mfma_f32_16x16x32_bf16 v[160:163], a[48:51], v[212:215], v[160:163]
buffer_load_dwordx4 v63, s[48:51], s31 offen offset:3072  lds
v_mfma_f32_16x16x32_bf16 v[176:179], a[48:51], v[216:219], v[176:179]
ds_read_b128 v[192:195], v12 offset:16384
s_waitcnt lgkmcnt(5)
v_mfma_f32_16x16x32_bf16 v[176:179], a[32:35], v[220:223], v[176:179]
ds_read_b128 v[196:199], v12 offset:24576
v_mfma_f32_16x16x32_bf16 v[180:183], a[36:39], v[220:223], v[180:183]
v_mfma_f32_16x16x32_bf16 v[180:183], a[52:55], v[216:219], v[180:183]
ds_read_b128 v[200:203], v12 offset:25600
v_mfma_f32_16x16x32_bf16 v[164:167], a[52:55], v[212:215], v[164:167]
ds_read_b128 v[204:207], v12 offset:17408
v_mfma_f32_16x16x32_bf16 v[164:167], a[36:39], v[208:211], v[164:167]
ds_read_b64_tr_b16 a[136:137], v58 offset:512
v_mfma_f32_16x16x32_bf16 v[168:171], a[40:43], v[208:211], v[168:171]
v_mfma_f32_16x16x32_bf16 v[168:171], a[56:59], v[212:215], v[168:171]
ds_read_b64_tr_b16 a[138:139], v58 offset:2560
v_mfma_f32_16x16x32_bf16 v[184:187], a[56:59], v[216:219], v[184:187]
ds_read_b64_tr_b16 a[140:141], v59 offset:512
v_mfma_f32_16x16x32_bf16 v[184:187], a[40:43], v[220:223], v[184:187]
ds_read_b64_tr_b16 a[142:143], v59 offset:2560
v_mfma_f32_16x16x32_bf16 v[188:191], a[44:47], v[220:223], v[188:191]
v_mfma_f32_16x16x32_bf16 v[188:191], a[60:63], v[216:219], v[188:191]
v_mfma_f32_16x16x32_bf16 v[172:175], a[60:63], v[212:215], v[172:175]
v_mfma_f32_16x16x32_bf16 v[172:175], a[44:47], v[208:211], v[172:175]
s_waitcnt lgkmcnt(7)
v_mfma_f32_16x16x32_bf16 v[128:131], a[64:67], v[192:195], v[128:131]
s_waitcnt lgkmcnt(6)
v_mfma_f32_16x16x32_bf16 v[128:131], a[80:83], v[196:199], v[128:131]
ds_read_b128 v[208:211], v13 offset:16384
s_waitcnt lgkmcnt(6)
v_mfma_f32_16x16x32_bf16 v[144:147], a[80:83], v[200:203], v[144:147]
ds_read_b128 v[212:215], v13 offset:24576
s_waitcnt lgkmcnt(5)
v_mfma_f32_16x16x32_bf16 v[144:147], a[64:67], v[204:207], v[144:147]
ds_read_b128 v[216:219], v13 offset:25600
v_mfma_f32_16x16x32_bf16 v[148:151], a[68:71], v[204:207], v[148:151]
v_mfma_f32_16x16x32_bf16 v[148:151], a[84:87], v[200:203], v[148:151]
ds_read_b128 v[220:223], v13 offset:17408
v_mfma_f32_16x16x32_bf16 v[132:135], a[84:87], v[196:199], v[132:135]
v_mfma_f32_16x16x32_bf16 v[132:135], a[68:71], v[192:195], v[132:135]
v_mfma_f32_16x16x32_bf16 v[136:139], a[72:75], v[192:195], v[136:139]
v_mfma_f32_16x16x32_bf16 v[136:139], a[88:91], v[196:199], v[136:139]
v_mfma_f32_16x16x32_bf16 v[152:155], a[88:91], v[200:203], v[152:155]
v_mfma_f32_16x16x32_bf16 v[152:155], a[72:75], v[204:207], v[152:155]
v_mfma_f32_16x16x32_bf16 v[156:159], a[76:79], v[204:207], v[156:159]
v_mfma_f32_16x16x32_bf16 v[156:159], a[92:95], v[200:203], v[156:159]
v_mfma_f32_16x16x32_bf16 v[140:143], a[92:95], v[196:199], v[140:143]
v_mfma_f32_16x16x32_bf16 v[140:143], a[76:79], v[192:195], v[140:143]
s_waitcnt lgkmcnt(3)
v_mfma_f32_16x16x32_bf16 v[160:163], a[64:67], v[208:211], v[160:163]
s_waitcnt vmcnt(8)
s_barrier
s_waitcnt lgkmcnt(2)
v_mfma_f32_16x16x32_bf16 v[160:163], a[80:83], v[212:215], v[160:163]
ds_read_b128 v[192:195], v13 offset:32768
s_waitcnt lgkmcnt(2)
v_mfma_f32_16x16x32_bf16 v[176:179], a[80:83], v[216:219], v[176:179]
ds_read_b128 v[196:199], v13 offset:40960
s_waitcnt lgkmcnt(2)
v_mfma_f32_16x16x32_bf16 v[176:179], a[64:67], v[220:223], v[176:179]
v_mfma_f32_16x16x32_bf16 v[180:183], a[68:71], v[220:223], v[180:183]
ds_read_b128 v[200:203], v13 offset:41984
s_lshl_b32 s25, s24, 13
v_mfma_f32_16x16x32_bf16 v[180:183], a[84:87], v[216:219], v[180:183]
ds_read_b128 v[204:207], v13 offset:33792
s_add_u32 s25, s25, 65536
v_mfma_f32_16x16x32_bf16 v[164:167], a[84:87], v[212:215], v[164:167]
v_add_u32 v10, s25, v3
v_mfma_f32_16x16x32_bf16 v[164:167], a[68:71], v[208:211], v[164:167]
v_xor_b32 v11, 16384, v10
v_mfma_f32_16x16x32_bf16 v[168:171], a[72:75], v[208:211], v[168:171]
s_lshl_b32 s25, s26, 6
v_mfma_f32_16x16x32_bf16 v[168:171], a[88:91], v[212:215], v[168:171]
s_waitcnt vmcnt(0)
ds_read_b64_tr_b16 a[144:145], v58 offset:16384
v_mfma_f32_16x16x32_bf16 v[184:187], a[88:91], v[216:219], v[184:187]
s_lshl_b32 s8, s29, 5
v_mfma_f32_16x16x32_bf16 v[184:187], a[72:75], v[220:223], v[184:187]
ds_read_b64_tr_b16 a[146:147], v58 offset:18432
s_add_u32 s25, s25, s8
v_mfma_f32_16x16x32_bf16 v[188:191], a[76:79], v[220:223], v[188:191]
ds_read_b64_tr_b16 a[148:149], v59 offset:16384
v_and_b32 v16, 15, v2
v_mfma_f32_16x16x32_bf16 v[188:191], a[92:95], v[216:219], v[188:191]
ds_read_b64_tr_b16 a[150:151], v59 offset:18432
v_add_u32 v16, s25, v16
v_mfma_f32_16x16x32_bf16 v[172:175], a[92:95], v[212:215], v[172:175]
v_lshlrev_b32 v16, 11, v16
v_mfma_f32_16x16x32_bf16 v[172:175], a[76:79], v[208:211], v[172:175]
ds_read_b64_tr_b16 a[152:153], v58 offset:16896
v_bfe_u32 v17, v2, 4, 1
s_waitcnt lgkmcnt(5)
v_mfma_f32_16x16x32_bf16 v[160:163], a[96:99], v[192:195], v[160:163]
s_barrier
v_mfma_f32_16x16x32_bf16 v[160:163], a[112:115], v[196:199], v[160:163]
ds_read_b128 v[208:211], v13 offset:49152
v_lshl_add_u32 v16, v17, 5, v16
v_mfma_f32_16x16x32_bf16 v[176:179], a[112:115], v[200:203], v[176:179]
v_lshrrev_b32 v17, 5, v2
v_mfma_f32_16x16x32_bf16 v[176:179], a[96:99], v[204:207], v[176:179]
ds_read_b128 v[212:215], v13 offset:57344
v_lshl_add_u32 v16, v17, 4, v16
v_mfma_f32_16x16x32_bf16 v[180:183], a[100:103], v[204:207], v[180:183]
ds_read_b128 v[216:219], v13 offset:58368
v_add_u32 v16, s70, v16
v_mfma_f32_16x16x32_bf16 v[180:183], a[116:119], v[200:203], v[180:183]
ds_read_b128 v[220:223], v13 offset:50176
v_add_u32 v17, 0x8000, v16
v_mfma_f32_16x16x32_bf16 v[164:167], a[116:119], v[196:199], v[164:167]
v_mfma_f32_16x16x32_bf16 v[164:167], a[100:103], v[192:195], v[164:167]
ds_read_b64_tr_b16 a[154:155], v58 offset:18944
v_mfma_f32_16x16x32_bf16 v[168:171], a[104:107], v[192:195], v[168:171]
ds_read_b64_tr_b16 a[156:157], v59 offset:16896
v_mfma_f32_16x16x32_bf16 v[168:171], a[120:123], v[196:199], v[168:171]
ds_read_b64_tr_b16 a[158:159], v59 offset:18944
v_mfma_f32_16x16x32_bf16 v[184:187], a[120:123], v[200:203], v[184:187]
v_mfma_f32_16x16x32_bf16 v[184:187], a[104:107], v[204:207], v[184:187]
v_mfma_f32_16x16x32_bf16 v[188:191], a[108:111], v[204:207], v[188:191]
v_mfma_f32_16x16x32_bf16 v[188:191], a[124:127], v[200:203], v[188:191]
v_mfma_f32_16x16x32_bf16 v[172:175], a[124:127], v[196:199], v[172:175]
v_mfma_f32_16x16x32_bf16 v[172:175], a[108:111], v[192:195], v[172:175]
s_waitcnt lgkmcnt(5)
v_mfma_f32_16x16x32_bf16 v[160:163], a[128:131], v[208:211], v[160:163]
ds_read_b128 v[192:195], v12 offset:32768
v_mfma_f32_16x16x32_bf16 v[160:163], a[144:147], v[212:215], v[160:163]
s_waitcnt lgkmcnt(5)
v_mfma_f32_16x16x32_bf16 v[176:179], a[144:147], v[216:219], v[176:179]
ds_read_b128 v[196:199], v12 offset:40960
s_waitcnt lgkmcnt(5)
v_mfma_f32_16x16x32_bf16 v[176:179], a[128:131], v[220:223], v[176:179]
ds_read_b128 v[200:203], v12 offset:49152
v_mfma_f32_16x16x32_bf16 v[180:183], a[132:135], v[220:223], v[180:183]
ds_read_b128 v[204:207], v12 offset:57344
v_mfma_f32_16x16x32_bf16 v[180:183], a[148:151], v[216:219], v[180:183]
v_mfma_f32_16x16x32_bf16 v[164:167], a[148:151], v[212:215], v[164:167]
v_mfma_f32_16x16x32_bf16 v[164:167], a[132:135], v[208:211], v[164:167]
v_mfma_f32_16x16x32_bf16 v[168:171], a[136:139], v[208:211], v[168:171]
ds_write_b128 v10, v[160:163] offset:0
s_waitcnt lgkmcnt(5)
v_mfma_f32_16x16x32_bf16 v[168:171], a[152:155], v[212:215], v[168:171]
v_mfma_f32_16x16x32_bf16 v[184:187], a[152:155], v[216:219], v[184:187]
ds_write_b128 v10, v[176:179] offset:4096
v_mfma_f32_16x16x32_bf16 v[184:187], a[136:139], v[220:223], v[184:187]
v_mfma_f32_16x16x32_bf16 v[188:191], a[140:143], v[220:223], v[188:191]
ds_write_b128 v10, v[164:167] offset:1024
v_mfma_f32_16x16x32_bf16 v[188:191], a[156:159], v[216:219], v[188:191]
v_mfma_f32_16x16x32_bf16 v[172:175], a[156:159], v[212:215], v[172:175]
ds_write_b128 v10, v[180:183] offset:5120
v_mfma_f32_16x16x32_bf16 v[172:175], a[140:143], v[208:211], v[172:175]
s_waitcnt lgkmcnt(6)
v_mfma_f32_16x16x32_bf16 v[128:131], a[96:99], v[192:195], v[128:131]
ds_read_b128 v[208:211], v12 offset:33792
v_mfma_f32_16x16x32_bf16 v[128:131], a[112:115], v[196:199], v[128:131]
ds_read_b128 v[212:215], v12 offset:41984
s_waitcnt lgkmcnt(6)
v_mfma_f32_16x16x32_bf16 v[128:131], a[128:131], v[200:203], v[128:131]
ds_read_b128 v[216:219], v12 offset:50176
v_mfma_f32_16x16x32_bf16 v[128:131], a[144:147], v[204:207], v[128:131]
ds_read_b128 v[220:223], v12 offset:58368
v_mfma_f32_16x16x32_bf16 v[132:135], a[148:151], v[204:207], v[132:135]
ds_write_b128 v10, v[168:171] offset:2048
v_mfma_f32_16x16x32_bf16 v[132:135], a[132:135], v[200:203], v[132:135]
ds_write_b128 v10, v[184:187] offset:6144
v_mfma_f32_16x16x32_bf16 v[132:135], a[116:119], v[196:199], v[132:135]
ds_write_b128 v10, v[172:175] offset:3072
v_mfma_f32_16x16x32_bf16 v[132:135], a[100:103], v[192:195], v[132:135]
ds_write_b128 v10, v[188:191] offset:7168
v_mfma_f32_16x16x32_bf16 v[136:139], a[104:107], v[192:195], v[136:139]
v_mfma_f32_16x16x32_bf16 v[136:139], a[120:123], v[196:199], v[136:139]
v_mfma_f32_16x16x32_bf16 v[136:139], a[136:139], v[200:203], v[136:139]
v_mfma_f32_16x16x32_bf16 v[136:139], a[152:155], v[204:207], v[136:139]
s_waitcnt lgkmcnt(0)
s_barrier
v_mfma_f32_16x16x32_bf16 v[140:143], a[156:159], v[204:207], v[140:143]
ds_read_b128 v[64:67], v11 offset:0
v_mfma_f32_16x16x32_bf16 v[140:143], a[140:143], v[200:203], v[140:143]
ds_read_b128 v[68:71], v11 offset:1024
v_mfma_f32_16x16x32_bf16 v[140:143], a[124:127], v[196:199], v[140:143]
ds_read_b128 v[72:75], v11 offset:2048
v_mfma_f32_16x16x32_bf16 v[140:143], a[108:111], v[192:195], v[140:143]
ds_read_b128 v[76:79], v11 offset:3072
v_mfma_f32_16x16x32_bf16 v[144:147], a[96:99], v[208:211], v[144:147]
ds_read_b128 v[80:83], v11 offset:4096
v_mfma_f32_16x16x32_bf16 v[144:147], a[112:115], v[212:215], v[144:147]
ds_read_b128 v[84:87], v11 offset:5120
v_mfma_f32_16x16x32_bf16 v[144:147], a[128:131], v[216:219], v[144:147]
ds_read_b128 v[88:91], v11 offset:6144
v_mfma_f32_16x16x32_bf16 v[144:147], a[144:147], v[220:223], v[144:147]
ds_read_b128 v[92:95], v11 offset:7168
s_waitcnt lgkmcnt(7)
v_add_f32 v128, v128, v64
v_mfma_f32_16x16x32_bf16 v[148:151], a[148:151], v[220:223], v[148:151]
v_add_f32 v129, v129, v65
v_add_f32 v130, v130, v66
v_mfma_f32_16x16x32_bf16 v[148:151], a[132:135], v[216:219], v[148:151]
v_add_f32 v131, v131, v67
s_waitcnt lgkmcnt(6)
v_add_f32 v132, v132, v68
v_mfma_f32_16x16x32_bf16 v[148:151], a[116:119], v[212:215], v[148:151]
v_add_f32 v133, v133, v69
v_add_f32 v134, v134, v70
v_mfma_f32_16x16x32_bf16 v[148:151], a[100:103], v[208:211], v[148:151]
v_add_f32 v135, v135, v71
v_cvt_pk_bf16_f32 v128, v128, v129
v_mfma_f32_16x16x32_bf16 v[152:155], a[104:107], v[208:211], v[152:155]
v_cvt_pk_bf16_f32 v129, v130, v131
v_cvt_pk_bf16_f32 v130, v132, v133
v_mfma_f32_16x16x32_bf16 v[152:155], a[120:123], v[212:215], v[152:155]
v_cvt_pk_bf16_f32 v131, v134, v135
v_permlane16_swap_b32 v128, v130
v_mfma_f32_16x16x32_bf16 v[152:155], a[136:139], v[216:219], v[152:155]
v_permlane16_swap_b32 v129, v131
v_mfma_f32_16x16x32_bf16 v[152:155], a[152:155], v[220:223], v[152:155]
buffer_store_dwordx4 v[128:131], v16, s[56:59], 0 offen offset:0 sc1
v_mfma_f32_16x16x32_bf16 v[156:159], a[156:159], v[220:223], v[156:159]
s_waitcnt lgkmcnt(0)
v_add_f32 v136, v136, v72
v_add_f32 v137, v137, v73
v_mfma_f32_16x16x32_bf16 v[156:159], a[140:143], v[216:219], v[156:159]
v_add_f32 v138, v138, v74
v_add_f32 v139, v139, v75
v_mfma_f32_16x16x32_bf16 v[156:159], a[124:127], v[212:215], v[156:159]
v_add_f32 v140, v140, v76
v_add_f32 v141, v141, v77
v_mfma_f32_16x16x32_bf16 v[156:159], a[108:111], v[208:211], v[156:159]
v_add_f32 v142, v142, v78
v_add_f32 v143, v143, v79
v_cvt_pk_bf16_f32 v136, v136, v137
v_cvt_pk_bf16_f32 v137, v138, v139
v_cvt_pk_bf16_f32 v138, v140, v141
v_cvt_pk_bf16_f32 v139, v142, v143
s_nop 0
v_permlane16_swap_b32 v136, v138
v_permlane16_swap_b32 v137, v139
buffer_store_dwordx4 v[136:139], v16, s[56:59], 0 offen offset:64 sc1
v_pk_add_f32 v[144:145], v[144:145], v[80:81]
v_pk_add_f32 v[146:147], v[146:147], v[82:83]
v_pk_add_f32 v[148:149], v[148:149], v[84:85]
v_pk_add_f32 v[150:151], v[150:151], v[86:87]
v_cvt_pk_bf16_f32 v144, v144, v145
v_cvt_pk_bf16_f32 v145, v146, v147
v_cvt_pk_bf16_f32 v146, v148, v149
v_cvt_pk_bf16_f32 v147, v150, v151
v_pk_add_f32 v[152:153], v[152:153], v[88:89]
v_permlane16_swap_b32 v144, v146
v_permlane16_swap_b32 v145, v147
v_pk_add_f32 v[154:155], v[154:155], v[90:91]
v_pk_add_f32 v[156:157], v[156:157], v[92:93]
v_pk_add_f32 v[158:159], v[158:159], v[94:95]
v_cvt_pk_bf16_f32 v152, v152, v153
v_cvt_pk_bf16_f32 v153, v154, v155
buffer_store_dwordx4 v[144:147], v17, s[56:59], 0 offen offset:0 sc1
v_cvt_pk_bf16_f32 v154, v156, v157
v_cvt_pk_bf16_f32 v155, v158, v159
s_nop 0
v_permlane16_swap_b32 v152, v154
v_permlane16_swap_b32 v153, v155
buffer_store_dwordx4 v[152:155], v17, s[56:59], 0 offen offset:64 sc1
L_end:
s_endpgm
ARM_spin:
s_mov_b32 s34, 0
ARM_again:
buffer_load_dword v31, v29, s[52:55], 0 offen sc1
s_add_u32 s34, s34, 1
s_waitcnt vmcnt(0)
v_and_b32 v30, 0xff, v31
v_cmp_ne_u32 vcc, 16, v30
s_cmp_gt_u32 s34, 200000
s_cbranch_scc1 ARM_ok
s_cbranch_vccnz ARM_again
s_branch ARM_ok
S1_far:
buffer_wbl2 sc1
s_waitcnt vmcnt(0)
buffer_store_dword v1, v9, s[16:19], s60 offen sc1
s_branch S1_done
S2_far:
buffer_wbl2 sc1
s_waitcnt vmcnt(0)
buffer_store_dword v1, v9, s[16:19], s60 offen sc1
s_branch S2_done
P3_spin:
s_mov_b32 s34, 0
P3_again:
buffer_load_dword v56, v42, s[16:19], s37 offen offset:0 sc1
s_add_u32 s34, s34, 1
s_waitcnt vmcnt(0)
v_cmp_gt_u32 vcc, 1, v56
s_cbranch_vccz P3_out
s_cmp_le_u32 s34, 200000
s_cbranch_scc1 P3_again
P3_out:
s_cmp_eq_u32 s35, 0
s_cbranch_scc1 P3_ok
buffer_inv sc1
s_branch P3_ok
P4_spin:
s_mov_b32 s34, 0
P4_again:
buffer_load_dword v57, v6, s[16:19], s37 offen offset:0 sc1
s_add_u32 s34, s34, 1
s_waitcnt vmcnt(0)
v_cmp_gt_u32 vcc, 2, v57
s_cbranch_vccz P4_out
s_cmp_le_u32 s34, 200000
s_cbranch_scc1 P4_again
P4_out:
s_cmp_eq_u32 s35, 0
s_cbranch_scc1 P4_ok
buffer_inv sc1
s_branch P4_ok
Z_red:
s_add_u32 s11, s3, 12288
buffer_load_dwordx4 v[184:187], v10, s[16:19], s11 offen sc1
s_add_u32 s11, s3, 112640
buffer_load_dwordx4 v[188:191], v10, s[16:19], s11 offen sc1
s_add_u32 s11, s3, 212992
buffer_load_dwordx4 v[232:235], v10, s[16:19], s11 offen sc1
s_add_u32 s11, s3, 313344
buffer_load_dwordx4 v[236:239], v10, s[16:19], s11 offen sc1
s_waitcnt vmcnt(0)
v_add_f32 v184, v184, v232
v_add_f32 v185, v185, v233
v_add_f32 v186, v186, v234
v_add_f32 v187, v187, v235
v_add_f32 v188, v188, v236
v_add_f32 v189, v189, v237
v_add_f32 v190, v190, v238
v_add_f32 v191, v191, v239
v_add_f32 v184, v184, v188
v_add_f32 v185, v185, v189
v_add_f32 v186, v186, v190
v_add_f32 v187, v187, v191
v_permlane32_swap_b32 v184, v185
v_add_f32 v184, v184, v185
v_permlane32_swap_b32 v186, v187
v_add_f32 v186, v186, v187
s_nop 1
v_permlane16_swap_b32 v184, v186
v_add_f32 v184, v184, v186
s_nop 1
v_add_f32_dpp v184, v184, v184 row_ror:8 row_mask:0xf bank_mask:0xf
v_cvt_pk_bf16_f32 v184, v184, v184
v_lshrrev_b32 v232, 4, v8
v_and_b32 v233, 7, v8
v_lshl_add_u32 v232, v232, 3, v233
s_add_u32 s11, s3, 24960
buffer_store_short v184, v232, s[16:19], s11 offen
s_branch Z_ret
S5_far:
buffer_wbl2 sc1
s_waitcnt vmcnt(0)
buffer_store_dword v1, v9, s[16:19], s60 offen sc1
s_branch S5_done
G_spin:
s_mov_b32 s34, 0
G_again:
buffer_load_dwordx2 v[92:93], v55, s[16:19], s100 offen offset:0 sc1
buffer_load_dwordx2 v[94:95], v55, s[16:19], s100 offen offset:256 sc1
s_add_u32 s34, s34, 1
s_waitcnt vmcnt(0)
v_and_b32 v93, v93, v95
v_cmp_ne_u32 vcc, 1, v93
s_cmp_gt_u32 s34, 200000
s_cbranch_scc1 G_ok
s_cbranch_vccnz G_again
s_branch G_ok
P6_spin:
s_mov_b32 s34, 0
P6_again:
buffer_load_dword v91, v6, s[16:19], s37 offen offset:0 sc1
s_add_u32 s34, s34, 1
s_waitcnt vmcnt(0)
v_cmp_gt_u32 vcc, 3, v91
s_cbranch_vccz P6_out
s_cmp_le_u32 s34, 200000
s_cbranch_scc1 P6_again
P6_out:
s_cmp_eq_u32 s35, 0
s_cbranch_scc1 P6_ok
buffer_inv sc1
s_branch P6_ok
P7_spin:
s_mov_b32 s34, 0
P7_again:
buffer_load_dword v10, v7, s[16:19], s38 offen offset:512 sc1
s_add_u32 s34, s34, 1
s_waitcnt vmcnt(0)
v_cmp_gt_u32 vcc, 1, v10
s_cbranch_vccz P7_out
s_cmp_le_u32 s34, 200000
s_cbranch_scc1 P7_again
P7_out:
s_branch P7_ok
P8_spin:
s_mov_b32 s34, 0
P8_again:
buffer_load_dword v10, v7, s[16:19], s38 offen offset:1536 sc1
s_add_u32 s34, s34, 1
s_waitcnt vmcnt(0)
v_cmp_gt_u32 vcc, 1, v10
s_cbranch_vccz P8_out
s_cmp_le_u32 s34, 200000
s_cbranch_scc1 P8_again
P8_out:
s_branch P8_ok
L_tail:
SLOW:
s_nop 15
v_lshrrev_b32 v13, 2, v2
v_lshrrev_b32 v12, 4, v2
v_xor_b32 v12, v12, v13
v_and_b32 v12, 1, v12
v_add_u32 v12, -1, v12
v_and_b32 v12, 0x3f803f80, v12
v_mov_b32 v13, v12
v_mov_b32 v14, v12
v_mov_b32 v15, v12
v_and_b32 v237, 1023, v4
v_mov_b32 v236, 0xff800000
v_bfe_i32 v144, v32, 0, 16
v_ashrrev_i32 v145, 16, v32
v_bfe_i32 v146, v33, 0, 16
v_ashrrev_i32 v147, 16, v33
v_bfe_i32 v148, v34, 0, 16
v_ashrrev_i32 v149, 16, v34
v_bfe_i32 v150, v35, 0, 16
v_ashrrev_i32 v151, 16, v35
v_bfe_i32 v152, v36, 0, 16
v_ashrrev_i32 v153, 16, v36
v_bfe_i32 v154, v37, 0, 16
v_ashrrev_i32 v155, 16, v37
v_bfe_i32 v156, v38, 0, 16
v_ashrrev_i32 v157, 16, v38
v_bfe_i32 v158, v39, 0, 16
v_ashrrev_i32 v159, 16, v39
v_mov_b32 v232, v236
v_mov_b32 v96, 0
v_mov_b32 v97, 0
v_mov_b32 v98, 0
v_mov_b32 v99, 0
v_mov_b32 v100, 0
v_mov_b32 v101, 0
v_mov_b32 v102, 0
v_mov_b32 v103, 0
v_mov_b32 v104, 0
v_mov_b32 v105, 0
v_mov_b32 v106, 0
v_mov_b32 v107, 0
v_mov_b32 v108, 0
v_mov_b32 v109, 0
v_mov_b32 v110, 0
v_mov_b32 v111, 0
v_mov_b32 v40, 0
v_mov_b32 v41, 0
v_mov_b32 v42, 0
v_mov_b32 v43, 0
s_lshl_b32 s8, s61, 1
s_add_u32 s8, s8, 0
s_mov_b32 s9, 0
SLOW_00:
s_lshr_b32 s10, s8, 1
s_mul_i32 s10, s10, 12544
s_and_b32 s11, s8, 1
s_lshl_b32 s11, s11, 12
s_add_u32 s10, s10, s11
s_add_u32 s10, s10, s3
buffer_load_dwordx4 v[208:211], v237, s[16:19], s10 offen offset:0 sc1
buffer_load_dwordx4 v[212:215], v237, s[16:19], s10 offen offset:1024 sc1
s_cmp_eq_u32 s9, 8
s_cselect_b32 s11, 0, -1
v_mov_b32 v234, s11
s_cmp_eq_u32 s9, 0
s_cselect_b32 s11, 0, -1
v_mov_b32 v235, s11
s_waitcnt vmcnt(0)
v_mfma_f32_32x32x16_bf16 v[128:143], v[208:211], v[16:19], 0
v_mfma_f32_32x32x16_bf16 v[128:143], v[212:215], v[20:23], v[128:143]
v_bfi_b32 v238, v144, v234, v235
s_nop 10
v_bfi_b32 v128, v238, v128, v236
v_max_f32 v232, v232, v128
v_bfi_b32 v238, v145, v234, v235
v_bfi_b32 v129, v238, v129, v236
v_max_f32 v232, v232, v129
v_bfi_b32 v238, v146, v234, v235
v_bfi_b32 v130, v238, v130, v236
v_max_f32 v232, v232, v130
v_bfi_b32 v238, v147, v234, v235
v_bfi_b32 v131, v238, v131, v236
v_max_f32 v232, v232, v131
v_bfi_b32 v238, v148, v234, v235
v_bfi_b32 v132, v238, v132, v236
v_max_f32 v232, v232, v132
v_bfi_b32 v238, v149, v234, v235
v_bfi_b32 v133, v238, v133, v236
v_max_f32 v232, v232, v133
v_bfi_b32 v238, v150, v234, v235
v_bfi_b32 v134, v238, v134, v236
v_max_f32 v232, v232, v134
v_bfi_b32 v238, v151, v234, v235
v_bfi_b32 v135, v238, v135, v236
v_max_f32 v232, v232, v135
v_bfi_b32 v238, v152, v234, v235
v_bfi_b32 v136, v238, v136, v236
v_max_f32 v232, v232, v136
v_bfi_b32 v238, v153, v234, v235
v_bfi_b32 v137, v238, v137, v236
v_max_f32 v232, v232, v137
v_bfi_b32 v238, v154, v234, v235
v_bfi_b32 v138, v238, v138, v236
v_max_f32 v232, v232, v138
v_bfi_b32 v238, v155, v234, v235
v_bfi_b32 v139, v238, v139, v236
v_max_f32 v232, v232, v139
v_bfi_b32 v238, v156, v234, v235
v_bfi_b32 v140, v238, v140, v236
v_max_f32 v232, v232, v140
v_bfi_b32 v238, v157, v234, v235
v_bfi_b32 v141, v238, v141, v236
v_max_f32 v232, v232, v141
v_bfi_b32 v238, v158, v234, v235
v_bfi_b32 v142, v238, v142, v236
v_max_f32 v232, v232, v142
v_bfi_b32 v238, v159, v234, v235
v_bfi_b32 v143, v238, v143, v236
v_max_f32 v232, v232, v143
s_add_u32 s9, s9, 1
s_cmp_eq_u32 s8, 0
s_cbranch_scc1 SLOW_00x
s_sub_u32 s8, s8, 1
s_cmp_le_u32 s9, 8
s_cbranch_scc1 SLOW_00
SLOW_00x:
v_mov_b32 v233, v232
s_nop 1
v_permlane32_swap_b32 v232, v233
v_max_f32 v232, v232, v233
s_lshl_b32 s8, s61, 1
s_add_u32 s8, s8, 0
s_mov_b32 s9, 0
SLOW_01:
s_lshr_b32 s10, s8, 1
s_mul_i32 s10, s10, 12544
s_and_b32 s11, s8, 1
s_lshl_b32 s11, s11, 12
s_add_u32 s10, s10, s11
s_add_u32 s10, s10, s3
buffer_load_dwordx4 v[208:211], v237, s[16:19], s10 offen offset:0 sc1
buffer_load_dwordx4 v[212:215], v237, s[16:19], s10 offen offset:1024 sc1
buffer_load_dwordx4 v[216:219], v237, s[16:19], s10 offen offset:2048 sc1
buffer_load_dwordx4 v[220:223], v237, s[16:19], s10 offen offset:3072 sc1
s_cmp_eq_u32 s9, 8
s_cselect_b32 s11, 0, -1
v_mov_b32 v234, s11
s_cmp_eq_u32 s9, 0
s_cselect_b32 s11, 0, -1
v_mov_b32 v235, s11
s_waitcnt vmcnt(0)
v_mfma_f32_32x32x16_bf16 v[128:143], v[208:211], v[16:19], 0
v_mfma_f32_32x32x16_bf16 v[128:143], v[212:215], v[20:23], v[128:143]
v_bfi_b32 v238, v144, v234, v235
s_nop 10
v_bfi_b32 v128, v238, v128, v236
v_sub_f32 v128, v128, v232
v_exp_f32 v128, v128
v_bfi_b32 v238, v145, v234, v235
v_bfi_b32 v129, v238, v129, v236
v_sub_f32 v129, v129, v232
v_exp_f32 v129, v129
v_bfi_b32 v238, v146, v234, v235
v_bfi_b32 v130, v238, v130, v236
v_sub_f32 v130, v130, v232
v_exp_f32 v130, v130
v_bfi_b32 v238, v147, v234, v235
v_bfi_b32 v131, v238, v131, v236
v_sub_f32 v131, v131, v232
v_exp_f32 v131, v131
v_bfi_b32 v238, v148, v234, v235
v_bfi_b32 v132, v238, v132, v236
v_sub_f32 v132, v132, v232
v_exp_f32 v132, v132
v_bfi_b32 v238, v149, v234, v235
v_bfi_b32 v133, v238, v133, v236
v_sub_f32 v133, v133, v232
v_exp_f32 v133, v133
v_bfi_b32 v238, v150, v234, v235
v_bfi_b32 v134, v238, v134, v236
v_sub_f32 v134, v134, v232
v_exp_f32 v134, v134
v_bfi_b32 v238, v151, v234, v235
v_bfi_b32 v135, v238, v135, v236
v_sub_f32 v135, v135, v232
v_exp_f32 v135, v135
v_bfi_b32 v238, v152, v234, v235
v_bfi_b32 v136, v238, v136, v236
v_sub_f32 v136, v136, v232
v_exp_f32 v136, v136
v_bfi_b32 v238, v153, v234, v235
v_bfi_b32 v137, v238, v137, v236
v_sub_f32 v137, v137, v232
v_exp_f32 v137, v137
v_bfi_b32 v238, v154, v234, v235
v_bfi_b32 v138, v238, v138, v236
v_sub_f32 v138, v138, v232
v_exp_f32 v138, v138
v_bfi_b32 v238, v155, v234, v235
v_bfi_b32 v139, v238, v139, v236
v_sub_f32 v139, v139, v232
v_exp_f32 v139, v139
v_bfi_b32 v238, v156, v234, v235
v_bfi_b32 v140, v238, v140, v236
v_sub_f32 v140, v140, v232
v_exp_f32 v140, v140
v_bfi_b32 v238, v157, v234, v235
v_bfi_b32 v141, v238, v141, v236
v_sub_f32 v141, v141, v232
v_exp_f32 v141, v141
v_bfi_b32 v238, v158, v234, v235
v_bfi_b32 v142, v238, v142, v236
v_sub_f32 v142, v142, v232
v_exp_f32 v142, v142
v_bfi_b32 v238, v159, v234, v235
v_bfi_b32 v143, v238, v143, v236
v_sub_f32 v143, v143, v232
v_exp_f32 v143, v143
v_cvt_pk_bf16_f32 v192, v128, v129
v_cvt_pk_bf16_f32 v193, v130, v131
v_cvt_pk_bf16_f32 v194, v132, v133
v_cvt_pk_bf16_f32 v195, v134, v135
s_nop 1
v_mfma_f32_32x32x16_bf16 v[96:111], v[216:219], v[192:195], v[96:111]
v_mfma_f32_16x16x32_bf16 v[40:43], v[12:15], v[192:195], v[40:43]
v_cvt_pk_bf16_f32 v196, v136, v137
v_cvt_pk_bf16_f32 v197, v138, v139
v_cvt_pk_bf16_f32 v198, v140, v141
v_cvt_pk_bf16_f32 v199, v142, v143
s_nop 1
v_mfma_f32_32x32x16_bf16 v[96:111], v[220:223], v[196:199], v[96:111]
v_mfma_f32_16x16x32_bf16 v[40:43], v[12:15], v[196:199], v[40:43]
s_nop 15
s_add_u32 s9, s9, 1
s_cmp_eq_u32 s8, 0
s_cbranch_scc1 SLOW_01x
s_sub_u32 s8, s8, 1
s_cmp_le_u32 s9, 8
s_cbranch_scc1 SLOW_01
SLOW_01x:
v_mov_b32 v232, v236
v_mov_b32 v112, 0
v_mov_b32 v113, 0
v_mov_b32 v114, 0
v_mov_b32 v115, 0
v_mov_b32 v116, 0
v_mov_b32 v117, 0
v_mov_b32 v118, 0
v_mov_b32 v119, 0
v_mov_b32 v120, 0
v_mov_b32 v121, 0
v_mov_b32 v122, 0
v_mov_b32 v123, 0
v_mov_b32 v124, 0
v_mov_b32 v125, 0
v_mov_b32 v126, 0
v_mov_b32 v127, 0
v_mov_b32 v44, 0
v_mov_b32 v45, 0
v_mov_b32 v46, 0
v_mov_b32 v47, 0
s_lshl_b32 s8, s61, 1
s_add_u32 s8, s8, 1
s_mov_b32 s9, 0
SLOW_10:
s_lshr_b32 s10, s8, 1
s_mul_i32 s10, s10, 12544
s_and_b32 s11, s8, 1
s_lshl_b32 s11, s11, 12
s_add_u32 s10, s10, s11
s_add_u32 s10, s10, s3
buffer_load_dwordx4 v[208:211], v237, s[16:19], s10 offen offset:0 sc1
buffer_load_dwordx4 v[212:215], v237, s[16:19], s10 offen offset:1024 sc1
s_cmp_eq_u32 s9, 8
s_cselect_b32 s11, 0, -1
v_mov_b32 v234, s11
s_cmp_eq_u32 s9, 0
s_cselect_b32 s11, 0, -1
v_mov_b32 v235, s11
s_waitcnt vmcnt(0)
v_mfma_f32_32x32x16_bf16 v[128:143], v[208:211], v[24:27], 0
v_mfma_f32_32x32x16_bf16 v[128:143], v[212:215], v[28:31], v[128:143]
v_bfi_b32 v238, v144, v234, v235
s_nop 10
v_bfi_b32 v128, v238, v128, v236
v_max_f32 v232, v232, v128
v_bfi_b32 v238, v145, v234, v235
v_bfi_b32 v129, v238, v129, v236
v_max_f32 v232, v232, v129
v_bfi_b32 v238, v146, v234, v235
v_bfi_b32 v130, v238, v130, v236
v_max_f32 v232, v232, v130
v_bfi_b32 v238, v147, v234, v235
v_bfi_b32 v131, v238, v131, v236
v_max_f32 v232, v232, v131
v_bfi_b32 v238, v148, v234, v235
v_bfi_b32 v132, v238, v132, v236
v_max_f32 v232, v232, v132
v_bfi_b32 v238, v149, v234, v235
v_bfi_b32 v133, v238, v133, v236
v_max_f32 v232, v232, v133
v_bfi_b32 v238, v150, v234, v235
v_bfi_b32 v134, v238, v134, v236
v_max_f32 v232, v232, v134
v_bfi_b32 v238, v151, v234, v235
v_bfi_b32 v135, v238, v135, v236
v_max_f32 v232, v232, v135
v_bfi_b32 v238, v152, v234, v235
v_bfi_b32 v136, v238, v136, v236
v_max_f32 v232, v232, v136
v_bfi_b32 v238, v153, v234, v235
v_bfi_b32 v137, v238, v137, v236
v_max_f32 v232, v232, v137
v_bfi_b32 v238, v154, v234, v235
v_bfi_b32 v138, v238, v138, v236
v_max_f32 v232, v232, v138
v_bfi_b32 v238, v155, v234, v235
v_bfi_b32 v139, v238, v139, v236
v_max_f32 v232, v232, v139
v_bfi_b32 v238, v156, v234, v235
v_bfi_b32 v140, v238, v140, v236
v_max_f32 v232, v232, v140
v_bfi_b32 v238, v157, v234, v235
v_bfi_b32 v141, v238, v141, v236
v_max_f32 v232, v232, v141
v_bfi_b32 v238, v158, v234, v235
v_bfi_b32 v142, v238, v142, v236
v_max_f32 v232, v232, v142
v_bfi_b32 v238, v159, v234, v235
v_bfi_b32 v143, v238, v143, v236
v_max_f32 v232, v232, v143
s_add_u32 s9, s9, 1
s_cmp_eq_u32 s8, 0
s_cbranch_scc1 SLOW_10x
s_sub_u32 s8, s8, 1
s_cmp_le_u32 s9, 8
s_cbranch_scc1 SLOW_10
SLOW_10x:
v_mov_b32 v233, v232
s_nop 1
v_permlane32_swap_b32 v232, v233
v_max_f32 v232, v232, v233
s_lshl_b32 s8, s61, 1
s_add_u32 s8, s8, 1
s_mov_b32 s9, 0
SLOW_11:
s_lshr_b32 s10, s8, 1
s_mul_i32 s10, s10, 12544
s_and_b32 s11, s8, 1
s_lshl_b32 s11, s11, 12
s_add_u32 s10, s10, s11
s_add_u32 s10, s10, s3
buffer_load_dwordx4 v[208:211], v237, s[16:19], s10 offen offset:0 sc1
buffer_load_dwordx4 v[212:215], v237, s[16:19], s10 offen offset:1024 sc1
buffer_load_dwordx4 v[216:219], v237, s[16:19], s10 offen offset:2048 sc1
buffer_load_dwordx4 v[220:223], v237, s[16:19], s10 offen offset:3072 sc1
s_cmp_eq_u32 s9, 8
s_cselect_b32 s11, 0, -1
v_mov_b32 v234, s11
s_cmp_eq_u32 s9, 0
s_cselect_b32 s11, 0, -1
v_mov_b32 v235, s11
s_waitcnt vmcnt(0)
v_mfma_f32_32x32x16_bf16 v[128:143], v[208:211], v[24:27], 0
v_mfma_f32_32x32x16_bf16 v[128:143], v[212:215], v[28:31], v[128:143]
v_bfi_b32 v238, v144, v234, v235
s_nop 10
v_bfi_b32 v128, v238, v128, v236
v_sub_f32 v128, v128, v232
v_exp_f32 v128, v128
v_bfi_b32 v238, v145, v234, v235
v_bfi_b32 v129, v238, v129, v236
v_sub_f32 v129, v129, v232
v_exp_f32 v129, v129
v_bfi_b32 v238, v146, v234, v235
v_bfi_b32 v130, v238, v130, v236
v_sub_f32 v130, v130, v232
v_exp_f32 v130, v130
v_bfi_b32 v238, v147, v234, v235
v_bfi_b32 v131, v238, v131, v236
v_sub_f32 v131, v131, v232
v_exp_f32 v131, v131
v_bfi_b32 v238, v148, v234, v235
v_bfi_b32 v132, v238, v132, v236
v_sub_f32 v132, v132, v232
v_exp_f32 v132, v132
v_bfi_b32 v238, v149, v234, v235
v_bfi_b32 v133, v238, v133, v236
v_sub_f32 v133, v133, v232
v_exp_f32 v133, v133
v_bfi_b32 v238, v150, v234, v235
v_bfi_b32 v134, v238, v134, v236
v_sub_f32 v134, v134, v232
v_exp_f32 v134, v134
v_bfi_b32 v238, v151, v234, v235
v_bfi_b32 v135, v238, v135, v236
v_sub_f32 v135, v135, v232
v_exp_f32 v135, v135
v_bfi_b32 v238, v152, v234, v235
v_bfi_b32 v136, v238, v136, v236
v_sub_f32 v136, v136, v232
v_exp_f32 v136, v136
v_bfi_b32 v238, v153, v234, v235
v_bfi_b32 v137, v238, v137, v236
v_sub_f32 v137, v137, v232
v_exp_f32 v137, v137
v_bfi_b32 v238, v154, v234, v235
v_bfi_b32 v138, v238, v138, v236
v_sub_f32 v138, v138, v232
v_exp_f32 v138, v138
v_bfi_b32 v238, v155, v234, v235
v_bfi_b32 v139, v238, v139, v236
v_sub_f32 v139, v139, v232
v_exp_f32 v139, v139
v_bfi_b32 v238, v156, v234, v235
v_bfi_b32 v140, v238, v140, v236
v_sub_f32 v140, v140, v232
v_exp_f32 v140, v140
v_bfi_b32 v238, v157, v234, v235
v_bfi_b32 v141, v238, v141, v236
v_sub_f32 v141, v141, v232
v_exp_f32 v141, v141
v_bfi_b32 v238, v158, v234, v235
v_bfi_b32 v142, v238, v142, v236
v_sub_f32 v142, v142, v232
v_exp_f32 v142, v142
v_bfi_b32 v238, v159, v234, v235
v_bfi_b32 v143, v238, v143, v236
v_sub_f32 v143, v143, v232
v_exp_f32 v143, v143
v_cvt_pk_bf16_f32 v192, v128, v129
v_cvt_pk_bf16_f32 v193, v130, v131
v_cvt_pk_bf16_f32 v194, v132, v133
v_cvt_pk_bf16_f32 v195, v134, v135
s_nop 1
v_mfma_f32_32x32x16_bf16 v[112:127], v[216:219], v[192:195], v[112:127]
v_mfma_f32_16x16x32_bf16 v[44:47], v[12:15], v[192:195], v[44:47]
v_cvt_pk_bf16_f32 v196, v136, v137
v_cvt_pk_bf16_f32 v197, v138, v139
v_cvt_pk_bf16_f32 v198, v140, v141
v_cvt_pk_bf16_f32 v199, v142, v143
s_nop 1
v_mfma_f32_32x32x16_bf16 v[112:127], v[220:223], v[196:199], v[112:127]
v_mfma_f32_16x16x32_bf16 v[44:47], v[12:15], v[196:199], v[44:47]
s_nop 15
s_add_u32 s9, s9, 1
s_cmp_eq_u32 s8, 0
s_cbranch_scc1 SLOW_11x
s_sub_u32 s8, s8, 1
s_cmp_le_u32 s9, 8
s_cbranch_scc1 SLOW_11
SLOW_11x:
s_nop 15
s_branch SLOW_ret
s_endpgm
.section .rodata,"a"
.p2align 6
.amdhsa_kernel gated_mix__linear_attn_block__sliding_block__prompt_kernel
  .amdhsa_next_free_vgpr 512
  .amdhsa_next_free_sgpr 102
  .amdhsa_accum_offset 256
  .amdhsa_group_segment_fixed_size 0
  .amdhsa_kernarg_size 80
  .amdhsa_user_sgpr_count 2
  .amdhsa_user_sgpr_kernarg_segment_ptr 1
  .amdhsa_system_sgpr_workgroup_id_x 1
.end_amdhsa_kernel
```
